```python
import torch

def _softmax(x, axis=-1):
    return torch.softmax(x, dim=axis)
def _gelu(x):
    return torch.nn.functional.gelu(x, approximate="tanh")
def _silu(x):
    return torch.nn.functional.silu(x)
def _sigmoid(x):
    return torch.sigmoid(x)
def _layernorm(x, axis=-1, eps=1e-5):
    m = x.mean(dim=axis, keepdim=True)
    v = x.var(dim=axis, keepdim=True, unbiased=False)
    return (x - m) / torch.sqrt(v + eps)
def _scatter_add(tgt, idx, src, axis=0):
    return tgt.clone().index_add_(axis, idx, src)
def _segment_sum(src, seg, n):
    out = torch.zeros((n,) + src.shape[1:], dtype=src.dtype)
    return out.index_add_(0, seg, src)
def _pad(x, pw):
    flat = tuple(v for pair in reversed(pw) for v in pair)
    return torch.nn.functional.pad(x, flat)

kernel_name = 'interleave_layers__sliding_block_cached__glu_gated_reglu__decode'

def setup_inputs():

    _w = (lambda a: (lambda t: t.to(torch.bfloat16) if t.is_floating_point() else t)(torch.as_tensor(a)))
    def _A_setup():
        B, Sq, D = 4, 1, 512
        Hq, Hkv, Sk, Dh = 32, 8, 16384, 128
        assert Hq % Hkv == 0, (Hq, Hkv)
        return {
            "x": _w((lambda *s: torch.randn(*s, dtype=torch.bfloat16) * 0.05)(B, Sq, D)),
            "k_cache": _w((lambda *s: torch.randn(*s, dtype=torch.bfloat16) * 0.8)(B, Hkv, Sk, Dh)),
            "v_cache": _w((lambda *s: torch.randn(*s, dtype=torch.bfloat16) * 0.8)(B, Hkv, Sk, Dh)),
            "wq": _w((lambda *s: torch.randn(*s, dtype=torch.bfloat16) * 0.8)(D, Hq * Dh) * (D ** -0.5)),
            "wo": _w((lambda *s: torch.randn(*s, dtype=torch.bfloat16) * 0.8)(Hq * Dh, D) * ((Hq * Dh) ** -0.5)),
        }
    _A_in = _A_setup()

    def _B_setup():
        B, S, D, F = 4, 1, 512, 1792
        return {
            "x": _w((lambda *s: torch.randn(*s, dtype=torch.bfloat16) * 0.05)(B, S, D)),
            "W_gate": _w((lambda *s: torch.randn(*s, dtype=torch.bfloat16) * 0.2)(D, F) * (2.0 / D) ** 0.5),
            "W_up": _w((lambda *s: torch.randn(*s, dtype=torch.bfloat16) * 0.2)(D, F) * (2.0 / D) ** 0.5),
            "W_down": _w((lambda *s: torch.randn(*s, dtype=torch.bfloat16) * 0.2)(F, D) * (1.0 / F) ** 0.5),
        }
    _B_in = _B_setup()

    return {
        "A_x": _A_in["x"],
        "A_k_cache": _A_in["k_cache"],
        "A_v_cache": _A_in["v_cache"],
        "A_wq": _A_in["wq"],
        "A_wo": _A_in["wo"],
        "B_x": _B_in["x"],
        "B_W_gate": _B_in["W_gate"],
        "B_W_up": _B_in["W_up"],
        "B_W_down": _B_in["W_down"],
    }

def reference(A_x, A_k_cache, A_v_cache, A_wq, A_wo, B_x, B_W_gate, B_W_up, B_W_down):
    def _A_ref(x, k_cache, v_cache, wq, wo):
        B, Sq, D = x.shape
        Hq, Dh = 32, 128
        Hkv, Sk = k_cache.shape[1], k_cache.shape[2]
        W = min(4096, max(256, Sk // 4))
        rep = Hq // Hkv
        q = (lambda x, *d: x.permute(*d))((x @ wq).reshape(B, Sq, Hq, Dh), 0, 2, 1, 3)
        k = (lambda x, n, axis: torch.repeat_interleave(x, n, dim=axis))(k_cache[:, :, Sk - W:, :], rep, axis=1)
        v = (lambda x, n, axis: torch.repeat_interleave(x, n, dim=axis))(v_cache[:, :, Sk - W:, :], rep, axis=1)
        scores = torch.einsum("bhqd,bhkd->bhqk", q, k) * (Dh ** -0.5)
        p = _softmax(scores, axis=-1)
        o = torch.einsum("bhqk,bhkd->bhqd", p, v)
        return (lambda x, *d: x.permute(*d))(o, 0, 2, 1, 3).reshape(B, Sq, Hq * Dh) @ wo

    def _B_ref(x, W_gate, W_up, W_down):
        gate = torch.einsum("bsd,df->bsf", x, W_gate)
        up = torch.einsum("bsd,df->bsf", x, W_up)
        gate = gate * (lambda x, dt: x.to(dt))(gate > 0, gate.dtype)
        h = gate * up
        return torch.einsum("bsf,fd->bsd", h, W_down)

    x = A_x
    x = x + _A_ref(_layernorm(x, axis=-1), A_k_cache, A_v_cache, A_wq, A_wo)
    x = x + _B_ref(_layernorm(x, axis=-1), B_W_gate, B_W_up, B_W_down)
    x = x + _A_ref(_layernorm(x, axis=-1), A_k_cache, A_v_cache, A_wq, A_wo)
    x = x + _B_ref(_layernorm(x, axis=-1), B_W_gate, B_W_up, B_W_down)
    return x
```

```asm
; @launch grid=(256,1,1) block=(512,1,1) lds=129536
.amdgcn_target "amdgcn-amd-amdhsa--gfx950"
.text
.globl interleave_layers__sliding_block_cached__glu_gated_reglu__decode_kernel
.p2align 8
.type interleave_layers__sliding_block_cached__glu_gated_reglu__decode_kernel,@function
interleave_layers__sliding_block_cached__glu_gated_reglu__decode_kernel:
s_cmp_ge_u32 s2, 256
s_cbranch_scc1 L_end
s_load_dwordx16 s[64:79], s[0:1], 0
s_load_dwordx8 s[80:87], s[0:1], 64
v_lshlrev_b32 v1, 2, v0
s_getpc_b64 s[94:95]
L_pc:
s_sub_u32 s94, s94, L_pc-interleave_layers__sliding_block_cached__glu_gated_reglu__decode_kernel
s_subb_u32 s95, s95, 0
s_lshr_b32 s93, s2, 3
s_and_b32 s93, s93, 1
s_lshl_b32 s93, s93, 13
v_lshlrev_b32 v30, 2, v1
v_add_u32 v30, s93, v30
v_min_u32 v30, L_end-interleave_layers__sliding_block_cached__glu_gated_reglu__decode_kernel-16, v30
global_load_dwordx4 v[96:99], v30, s[94:95]
v_lshrrev_b32 v30, 6, v0
v_and_b32 v0, 63, v0
v_readfirstlane_b32 s3, v30
s_and_b32 s4, s2, 7
s_lshr_b32 s5, s2, 3
s_lshr_b32 s6, s5, 3
s_and_b32 s7, s5, 7
v_and_b32 v120, 15, v0
v_lshrrev_b32 v121, 4, v0
v_lshlrev_b32 v30, 2, v121
v_xor_b32 v30, v120, v30
v_lshlrev_b32 v30, 4, v30
v_lshl_add_u32 v116, v121, 8, v30
v_lshl_add_u32 v124, v121, 13, v30
v_and_b32 v122, 3, v0
v_lshrrev_b32 v123, 2, v120
s_lshr_b32 s54, s3, 1
s_lshl_b32 s54, s54, 10
s_and_b32 s55, s3, 1
s_lshl_b32 s55, s55, 6
s_add_u32 s54, s54, s55
s_lshl_b32 s55, s7, 7
s_add_u32 s54, s54, s55
v_lshlrev_b32 v117, 4, v122
v_lshl_add_u32 v117, v121, 2, v117
v_add_u32 v23, s54, v117
s_lshl_b32 s54, s6, 3
s_add_u32 s54, s54, s4
s_lshl_b32 s52, s54, 22
s_lshl_b32 s54, s7, 17
s_add_u32 s52, s52, s54
s_add_u32 s52, s52, 3145728
s_add_u32 s54, s4, s5
s_add_u32 s54, s54, s3
s_and_b32 s54, s54, 7
s_lshl_b32 s54, s54, 12
s_add_u32 s52, s52, s54
s_lshl_b32 s53, s3, 13
s_and_b32 s93, s3, 3
s_lshl_b32 s54, s4, 2
s_add_u32 s54, s54, s6
v_mov_b32 v118, 2147418112
s_mul_i32 s101, s4, 109568
s_lshl_b32 s55, s7, 6
s_lshl_b32 s56, s3, 3
s_add_u32 s55, s55, s56
s_lshl_b32 s55, s55, 13
s_lshl_b32 s56, s4, 10
s_add_u32 s55, s55, s56
s_lshl_b32 s56, s6, 8
s_add_u32 s55, s55, s56
s_lshl_b32 s56, s3, 11
s_add_u32 m0, s56, 65536
s_waitcnt lgkmcnt(0)
s_mov_b32 s20, s70
s_mov_b32 s21, s71
s_mov_b32 s22, 4194304
s_mov_b32 s23, 0x20000
buffer_load_dwordx4 v124, s[20:23], s55 offen nt lds
s_add_u32 s55, s55, 32768
s_add_u32 m0, m0, 1024
s_mov_b32 s40, s64
s_mov_b32 s41, s65
s_mov_b32 s42, 4096
s_mov_b32 s43, 0x20000
buffer_load_dwordx4 v124, s[20:23], s55 offen nt lds
s_mov_b32 s8, s86
s_mov_b32 s9, s87
s_mov_b32 s10, 3588352
s_mov_b32 s11, 0x20000
buffer_load_dword v68, v23, s[40:43], 0 offen
s_lshr_b32 s56, s3, 1
s_lshl_b32 s56, s56, 10
v_lshlrev_b32 v30, 4, v0
buffer_load_dwordx4 v[72:75], v30, s[40:43], s56 offen
s_mov_b32 s56, 3588096
buffer_load_dword v69, off, s[8:11], s56 sc1
s_mov_b32 s12, s66
s_mov_b32 s13, s67
s_mov_b32 s14, 134217728
s_mov_b32 s15, 0x20000
s_add_u32 s91, s52, 0
s_add_u32 m0, s53, 0
s_nop 0
buffer_load_dwordx4 v116, s[12:15], s91 offen offset:0 nt lds
buffer_load_dwordx4 v116, s[12:15], s91 offen offset:1024 nt lds
buffer_load_dwordx4 v116, s[12:15], s91 offen offset:2048 nt lds
buffer_load_dwordx4 v116, s[12:15], s91 offen offset:3072 nt lds
s_mov_b32 s16, s68
s_mov_b32 s17, s69
s_mov_b32 s18, 134217728
s_mov_b32 s19, 0x20000
s_mov_b32 s24, s72
s_mov_b32 s25, s73
s_mov_b32 s26, 4194304
s_mov_b32 s27, 0x20000
s_mov_b32 s44, s82
s_mov_b32 s45, s83
s_mov_b32 s46, 4096
s_mov_b32 s47, 0x20000
s_mov_b32 s28, s76
s_mov_b32 s29, s77
s_mov_b32 s30, 1835008
s_mov_b32 s31, 0x20000
s_mov_b32 s32, s78
s_mov_b32 s33, s79
s_mov_b32 s34, 1835008
s_mov_b32 s35, 0x20000
s_mov_b32 s36, s80
s_mov_b32 s37, s81
s_mov_b32 s38, 1835008
s_mov_b32 s39, 0x20000
s_mul_i32 s55, s4, 3
s_add_u32 s55, s55, 4
s_lshl_b32 s56, s4, 2
s_cmp_ge_u32 s4, 4
s_cselect_b32 s92, s55, s56
s_add_u32 s92, s92, s6
s_min_u32 s92, s92, 27
s_getreg_b32 s55, hwreg(HW_REG_XCC_ID)
s_and_b32 s64, s55, 15
s_mov_b32 s88, 0x000f000f
s_mov_b32 s89, 0x000f000f
s_mov_b32 s73, s101
s_lshl_b32 s55, s6, 13
s_add_u32 s55, s55, s73
s_add_u32 s66, s55, 1138688
s_add_u32 s67, s55, 33792
s_add_u32 s68, s55, 67584
s_lshl_b32 s55, s93, 2
s_add_u32 s55, s55, s6
s_lshl_b32 s55, s55, 6
s_add_u32 s55, s55, s73
s_add_u32 s69, s55, 1171456
s_lshl_b32 s76, s7, 3
s_add_u32 s76, s76, s55
s_add_u32 s76, s76, 66560
s_lshl_b32 s56, s93, 13
s_lshl_b32 s55, s7, 10
s_add_u32 s56, s56, s55
s_lshl_b32 s55, s6, 8
s_add_u32 s56, s56, s55
s_add_u32 s56, s56, s73
s_add_u32 s75, s56, 33792
s_lshl_b32 s55, s6, 2
s_add_u32 s55, s55, s93
s_lshl_b32 s55, s55, 6
s_add_u32 s55, s55, s73
s_add_u32 s70, s55, 66560
s_add_u32 s71, s55, 100352
s_lshl_b32 s55, s7, 14
s_add_u32 s72, s55, 876544
s_lshl_b32 s55, s54, 9
s_add_u32 s77, s72, s55
s_lshl_b32 s55, s6, 11
s_add_u32 s55, s55, s73
s_add_u32 s74, s55, 101376
s_lshl_b32 s57, s6, 8
s_lshl_b32 s55, s7, 3
s_add_u32 s57, s57, s55
s_add_u32 s57, s57, s73
s_add_u32 s78, s57, 1171456
s_add_u32 s79, s57, 100352
s_lshl_b32 s101, s54, 14
s_add_u32 s101, s101, 2359296
s_lshl_b32 s55, s7, 10
s_lshl_b32 s56, s6, 8
s_add_u32 s55, s55, s56
s_lshl_b32 s56, s93, 6
s_add_u32 s57, s55, s56
s_add_u32 s55, s73, s57
s_add_u32 s55, s55, 1138688
s_mov_b32 s56, 2147418112
s_cmp_ge_u32 s3, 4
s_cselect_b32 s90, 0, 5
v_lshlrev_b32 v30, 13, v120
v_add_u32 v30, s55, v30
v_mov_b32 v31, s56
v_cmp_eq_u32 vcc, 4, v120
s_nop 1
v_cndmask_b32 v30, v30, v31, vcc
v_lshl_add_u32 v30, v121, 4, v30
v_cmp_gt_u32 vcc, s90, v120
s_nop 1
v_cndmask_b32 v4, v118, v30, vcc
s_lshl_b32 s57, s57, 1
s_lshl_b32 s55, s93, 6
s_sub_u32 s57, s57, s55
s_lshl_b32 s55, s4, 16
s_add_u32 s55, s55, s57
s_add_u32 s55, s55, 2359296
s_lshl_b32 s56, s4, 14
s_add_u32 s56, s56, s57
s_add_u32 s56, s56, 2883584
v_lshlrev_b32 v30, 14, v120
v_add_u32 v30, s55, v30
v_mov_b32 v31, s56
v_cmp_eq_u32 vcc, 4, v120
s_nop 1
v_cndmask_b32 v30, v30, v31, vcc
v_lshl_add_u32 v30, v121, 4, v30
v_cmp_gt_u32 vcc, s90, v120
s_nop 1
v_cndmask_b32 v109, v118, v30, vcc
v_lshlrev_b32 v30, 6, v122
v_add_u32 v31, 4, v30
v_cmp_gt_u32 vcc, 16, v0
s_nop 1
v_cndmask_b32 v30, v30, v31, vcc
v_and_b32 v31, 1968, v1
v_cmp_eq_u32 vcc, 1024, v31
s_nop 1
v_cndmask_b32 v6, v118, v30, vcc
v_lshlrev_b32 v115, 2, v1
s_lshl_b32 s55, s4, 2
s_add_u32 s55, s55, s93
s_lshl_b32 s55, s55, 14
s_lshl_b32 s56, s7, 11
s_add_u32 s55, s55, s56
s_lshl_b32 s56, s6, 9
s_add_u32 s55, s55, s56
s_add_u32 s55, s55, 3014656
v_and_b32 v30, 2, v0
v_lshlrev_b32 v30, 7, v30
v_lshrrev_b32 v31, 2, v0
v_lshl_add_u32 v30, v31, 4, v30
v_add_u32 v30, s55, v30
v_and_b32 v31, 1, v0
v_cmp_eq_u32 vcc, 0, v31
s_nop 1
v_cndmask_b32 v110, v118, v30, vcc
s_mov_b32 s58, 0
s_mov_b32 s59, 400000
s_mov_b32 s60, 0
s_mov_b32 s62, 0
s_mov_b32 s63, 0
s_lshl_b32 s57, s93, 6
s_lshl_b32 s55, s7, 10
s_add_u32 s55, s55, s68
s_add_u32 s55, s55, s57
s_lshl_b32 s56, s7, 8
s_add_u32 s56, s56, s74
s_add_u32 s56, s56, s57
v_lshlrev_b32 v30, 8, v120
v_add_u32 v30, s55, v30
v_mov_b32 v31, s56
v_cmp_eq_u32 vcc, 4, v120
s_nop 1
v_cndmask_b32 v30, v30, v31, vcc
v_lshl_add_u32 v30, v121, 4, v30
v_cmp_gt_u32 vcc, s90, v120
s_nop 1
v_cndmask_b32 v5, v118, v30, vcc
v_and_b32 v30, 7, v0
v_lshlrev_b32 v2, 3, v30
v_lshlrev_b32 v15, 2, v0
v_lshlrev_b32 v29, 3, v121
v_cmp_eq_u32 vcc, 0, v0
s_nop 1
v_cndmask_b32 v46, v118, 0, vcc
s_lshl_b32 s55, s93, 8
v_lshlrev_b32 v30, 4, v120
v_lshl_add_u32 v7, v121, 10, v30
v_add_u32 v7, s55, v7
s_lshl_b32 s55, s3, 6
v_lshlrev_b32 v3, 11, v123
v_lshl_add_u32 v3, v121, 9, v3
v_lshl_add_u32 v3, v122, 4, v3
v_add_u32 v3, s55, v3
s_lshr_b32 s55, s3, 1
s_mul_i32 s55, s55, 192
s_and_b32 s56, s3, 1
s_lshl_b32 s56, s56, 6
s_add_u32 s55, s55, s56
s_add_u32 s55, s55, 126208
v_add_u32 v14, s55, v117
v_add_u32 v31, 127488, v1
v_cmp_eq_u32 vcc, 0, v123
s_nop 1
v_cndmask_b32 v14, v31, v14, vcc
s_mul_i32 s55, s93, 320
s_add_u32 s55, s55, 122880
v_lshl_add_u32 v9, v121, 2, v30
v_add_u32 v9, s55, v9
s_mul_i32 s55, s93, 192
s_add_u32 s55, s55, 125440
v_lshlrev_b32 v11, 3, v120
v_lshl_add_u32 v11, v121, 1, v11
v_add_u32 v11, s55, v11
v_mul_u32_u24 v10, 320, v122
v_lshl_add_u32 v10, v121, 4, v10
v_add_u32 v10, 122880, v10
v_mul_u32_u24 v12, 192, v122
v_lshl_add_u32 v12, v121, 4, v12
v_add_u32 v12, 125440, v12
v_min_u32 v31, 4, v120
v_mul_u32_u24 v13, 192, v31
v_lshl_add_u32 v13, v121, 4, v13
v_add_u32 v13, 126208, v13
s_lshl_b32 s55, s93, 5
v_lshlrev_b32 v31, 7, v120
v_lshl_add_u32 v31, v121, 3, v31
v_add_u32 v31, s55, v31
v_cmp_gt_u32 vcc, 4, v120
s_nop 1
v_cndmask_b32 v8, v118, v31, vcc
v_lshlrev_b32 v31, 4, v0
v_add_u32 v16, s53, v31
s_lshr_b32 s55, s93, 1
s_lshl_b32 s55, s55, 10
s_and_b32 s56, s93, 1
s_lshl_b32 s56, s56, 3
s_add_u32 s55, s55, s56
v_add_u32 v17, s55, v31
s_lshl_b32 s55, s3, 3
s_add_u32 s55, s55, 127168
v_lshlrev_b32 v18, 6, v122
v_add_u32 v18, s55, v18
s_lshl_b32 s55, s93, 6
s_add_u32 s55, s55, 127168
v_add_u32 v19, s55, v2
v_lshl_add_u32 v125, v121, 3, v123
v_xor_b32 v30, s93, v123
v_lshlrev_b32 v30, 6, v30
v_lshl_add_u32 v30, v122, 4, v30
v_lshl_add_u32 v20, v125, 8, v30
v_add_u32 v20, 65536, v20
v_lshrrev_b32 v119, 1, v123
v_and_b32 v127, 1, v121
v_lshlrev_b32 v30, 1, v127
v_xor_b32 v30, s93, v30
v_lshlrev_b32 v30, 5, v30
v_lshl_add_u32 v30, v122, 3, v30
v_lshl_add_u32 v21, v125, 7, v30
v_add_u32 v21, 98304, v21
v_and_b32 v126, 1, v123
v_lshlrev_b32 v30, 1, v126
v_xor_b32 v30, s93, v30
v_lshlrev_b32 v30, 5, v30
v_lshl_add_u32 v30, v122, 3, v30
v_lshl_add_u32 v31, v121, 2, v119
v_lshl_add_u32 v31, v126, 6, v31
v_lshl_add_u32 v22, v31, 7, v30
v_add_u32 v22, 81920, v22
v_and_b32 v125, 1, v120
v_mov_b32 v30, 0xffff
v_mov_b32 v31, 0xffff0000
v_cmp_eq_u32 vcc, 1, v125
s_nop 1
v_cndmask_b32 v119, v30, v31, vcc
v_cmp_gt_u32 vcc, 2, v122
s_nop 1
v_cndmask_b32 v119, 0, v119, vcc
v_cmp_eq_u32 vcc, 0, v123
s_nop 1
v_cndmask_b32 v36, 0, v119, vcc
v_and_b32 v32, 0x3f803f80, v36
v_cmp_eq_u32 vcc, 1, v123
s_nop 1
v_cndmask_b32 v37, 0, v119, vcc
v_and_b32 v33, 0x3f803f80, v37
v_cmp_eq_u32 vcc, 2, v123
s_nop 1
v_cndmask_b32 v38, 0, v119, vcc
v_and_b32 v34, 0x3f803f80, v38
v_cmp_eq_u32 vcc, 3, v123
s_nop 1
v_cndmask_b32 v39, 0, v119, vcc
v_and_b32 v35, 0x3f803f80, v39
v_mov_b32 v30, 0x3f80
v_mov_b32 v31, 0x3f800000
v_cmp_eq_u32 vcc, 1, v126
s_nop 1
v_cndmask_b32 v119, v30, v31, vcc
v_cmp_gt_u32 vcc, 2, v122
s_nop 1
v_cndmask_b32 v119, 0, v119, vcc
v_lshrrev_b32 v30, 1, v123
v_lshl_add_u32 v30, v125, 1, v30
v_cmp_eq_u32 vcc, 0, v30
s_nop 1
v_cndmask_b32 v40, 0, v119, vcc
v_cmp_eq_u32 vcc, 1, v30
s_nop 1
v_cndmask_b32 v41, 0, v119, vcc
v_cmp_eq_u32 vcc, 2, v30
s_nop 1
v_cndmask_b32 v42, 0, v119, vcc
v_cmp_eq_u32 vcc, 3, v30
s_nop 1
v_cndmask_b32 v43, 0, v119, vcc
v_mov_b32 v44, 0x3f803f80
v_mov_b32 v45, 0x3f803f80
v_and_b32 v31, 7, v0
v_lshrrev_b32 v119, 3, v0
s_lshr_b32 s55, s3, 2
s_lshl_b32 s55, s55, 2
v_xor_b32 v30, s55, v31
v_lshlrev_b32 v30, 4, v30
v_lshl_add_u32 v124, v119, 10, v30
s_and_b32 s55, s3, 1
s_lshl_b32 s55, s55, 2
v_xor_b32 v30, s55, v31
v_lshlrev_b32 v30, 4, v30
v_lshl_add_u32 v127, v119, 10, v30
v_mul_u32_u24 v126, 3584, v119
v_add_u32 v126, v126, v30
s_cmp_ge_u32 s4, 4
s_cselect_b32 s56, 3, 4
s_cmp_lt_u32 s6, s56
s_cselect_b32 s56, 0, 2147418112
v_add_u32 v126, s56, v126
v_add_u32 v127, s56, v127
v_lshlrev_b32 v30, 1, v123
v_xor_b32 v30, v121, v30
v_lshlrev_b32 v30, 5, v30
v_lshl_add_u32 v30, v122, 3, v30
v_lshl_add_u32 v30, v123, 8, v30
v_add_u32 v122, s53, v30
v_xor_b32 v123, 128, v122
v_and_b32 v30, 3, v120
v_lshlrev_b32 v30, 6, v30
v_lshl_add_u32 v30, v121, 4, v30
v_lshl_add_u32 v30, v120, 8, v30
v_add_u32 v118, s53, v30
v_xor_b32 v119, 64, v118
v_xor_b32 v120, 128, v118
v_xor_b32 v121, 192, v118
v_and_b32 v30, 124, v15
v_add_u32 v30, 126976, v30
ds_write_b32 v30, v44
v_mov_b32 v30, 127440
v_mov_b32 v31, 0
ds_write_b32 v30, v31
v_mov_b32 v76, -1
v_mov_b32 v77, -1
ds_write_b64 v19, v[76:77]
s_add_u32 s91, s52, 32768
s_add_u32 m0, s53, 4096
s_nop 0
buffer_load_dwordx4 v116, s[12:15], s91 offen offset:0 nt lds
buffer_load_dwordx4 v116, s[12:15], s91 offen offset:1024 nt lds
buffer_load_dwordx4 v116, s[12:15], s91 offen offset:2048 nt lds
buffer_load_dwordx4 v116, s[12:15], s91 offen offset:3072 nt lds
s_waitcnt vmcnt(8)
v_and_b32 v113, 0xffff0000, v68
v_lshlrev_b32 v112, 16, v68
v_readfirstlane_b32 s100, v69
s_nop 0
s_add_u32 s100, s100, 1
v_dot2_f32_bf16 v78, v72, v44, 0
v_dot2_f32_bf16 v79, v72, v72, 0
v_dot2_f32_bf16 v78, v73, v44, v78
v_dot2_f32_bf16 v79, v73, v73, v79
v_dot2_f32_bf16 v78, v74, v44, v78
v_dot2_f32_bf16 v79, v74, v74, v79
v_dot2_f32_bf16 v78, v75, v44, v78
v_dot2_f32_bf16 v79, v75, v75, v79
s_nop 1
v_add_f32_dpp v78, v78, v78 quad_perm:[1,0,3,2] row_mask:0xf bank_mask:0xf
v_add_f32_dpp v79, v79, v79 quad_perm:[1,0,3,2] row_mask:0xf bank_mask:0xf
s_nop 0
v_add_f32_dpp v78, v78, v78 quad_perm:[2,3,0,1] row_mask:0xf bank_mask:0xf
v_add_f32_dpp v79, v79, v79 quad_perm:[2,3,0,1] row_mask:0xf bank_mask:0xf
s_nop 0
v_add_f32_dpp v78, v78, v78 row_half_mirror row_mask:0xf bank_mask:0xf
v_add_f32_dpp v79, v79, v79 row_half_mirror row_mask:0xf bank_mask:0xf
s_nop 0
v_add_f32_dpp v78, v78, v78 row_mirror row_mask:0xf bank_mask:0xf
v_add_f32_dpp v79, v79, v79 row_mirror row_mask:0xf bank_mask:0xf
v_mov_b32 v76, v78
v_mov_b32 v77, v79
s_nop 0
v_permlane16_swap_b32 v78, v76
v_permlane16_swap_b32 v79, v77
v_add_f32 v78, v78, v76
v_add_f32 v79, v79, v77
v_mov_b32 v76, v78
v_mov_b32 v77, v79
s_nop 0
v_permlane32_swap_b32 v78, v76
v_permlane32_swap_b32 v79, v77
v_add_f32 v78, v78, v76
v_add_f32 v79, v79, v77
v_mov_b32 v75, 0x3a21369a
v_mul_f32 v74, v78, v78
v_fmac_f32 v75, 0x3df5fdf0, v79
v_fmac_f32 v75, 0xb975fdf0, v74
v_max_f32 v75, 0x3a21369a, v75
v_rsq_f32 v74, v75
v_mul_f32 v78, 0xbb000000, v78
v_add_f32 v72, v112, v78
v_add_f32 v73, v113, v78
v_mul_f32 v72, v72, v74
v_mul_f32 v73, v73, v74
v_cvt_pk_bf16_f32 v72, v72, v73
ds_write_b32 v14, v72
s_waitcnt lgkmcnt(0)
s_barrier
s_cmp_ge_u32 s3, 4
s_cbranch_scc1 L_hi_1
ds_read_b64_tr_b16 v[48:49], v20 offset:0
ds_read_b64_tr_b16 v[50:51], v20 offset:1024
ds_read_b64_tr_b16 v[52:53], v20 offset:8192
ds_read_b64_tr_b16 v[54:55], v20 offset:9216
ds_read_b64_tr_b16 v[56:57], v20 offset:8
ds_read_b64_tr_b16 v[58:59], v20 offset:1032
ds_read_b64_tr_b16 v[60:61], v20 offset:8200
ds_read_b64_tr_b16 v[62:63], v20 offset:9224
s_waitcnt lgkmcnt(0)
ds_read_b128 v[80:83], v13
ds_read_b128 v[84:87], v13 offset:64
s_waitcnt lgkmcnt(1)
v_mfma_f32_16x16x32_bf16 v[96:99], v[48:51], v[80:83], 0
v_mfma_f32_16x16x32_bf16 v[104:107], v[56:59], v[80:83], 0
s_waitcnt lgkmcnt(0)
v_mfma_f32_16x16x32_bf16 v[96:99], v[52:55], v[84:87], v[96:99]
v_mfma_f32_16x16x32_bf16 v[104:107], v[60:63], v[84:87], v[104:107]
v_mov_b32 v102, s100
v_mov_b32 v103, s64
s_nop 4
v_cvt_pk_bf16_f32 v100, v96, v97
v_cvt_pk_bf16_f32 v101, v98, v99
v_cvt_pk_bf16_f32 v104, v104, v105
v_cvt_pk_bf16_f32 v105, v106, v107
v_mov_b32 v106, s100
v_mov_b32 v107, s64
buffer_store_dwordx4 v[100:103], v109, s[8:11], 0 offen
buffer_store_dwordx4 v[104:107], v109, s[8:11], 0 offen offset:256
L_hi_1:
s_cmp_ge_u32 s3, 4
s_cbranch_scc1 L_shi_2
s_waitcnt vmcnt(6)
ds_read_b128 a[0:3], v118 offset:0
ds_read_b128 a[4:7], v119 offset:0
ds_read_b128 a[8:11], v120 offset:0
ds_read_b128 a[12:15], v121 offset:0
s_waitcnt lgkmcnt(0)
s_add_u32 s91, s52, 65536
s_add_u32 m0, s53, 0
s_nop 0
buffer_load_dwordx4 v116, s[12:15], s91 offen offset:0 nt lds
buffer_load_dwordx4 v116, s[12:15], s91 offen offset:1024 nt lds
buffer_load_dwordx4 v116, s[12:15], s91 offen offset:2048 nt lds
buffer_load_dwordx4 v116, s[12:15], s91 offen offset:3072 nt lds
s_waitcnt vmcnt(6)
ds_read_b128 a[16:19], v118 offset:4096
ds_read_b128 a[20:23], v119 offset:4096
ds_read_b128 a[24:27], v120 offset:4096
ds_read_b128 a[28:31], v121 offset:4096
s_waitcnt lgkmcnt(0)
s_add_u32 s91, s52, 98304
s_add_u32 m0, s53, 4096
s_nop 0
buffer_load_dwordx4 v116, s[12:15], s91 offen offset:0 nt lds
s_waitcnt vmcnt(4)
buffer_load_dwordx4 v116, s[12:15], s91 offen offset:1024 nt lds
s_waitcnt vmcnt(4)
buffer_load_dwordx4 v116, s[12:15], s91 offen offset:2048 nt lds
s_waitcnt vmcnt(4)
buffer_load_dwordx4 v116, s[12:15], s91 offen offset:3072 nt lds
s_cmp_lg_u32 s62, 0
s_cbranch_scc1 L_noq_5
v_and_b32 v31, 0xf0, v7
v_lshlrev_b32 v30, 1, v7
v_sub_u32 v30, v30, v31
s_mov_b32 s55, s101
s_add_u32 s56, s55, 8192
buffer_load_dwordx4 v[80:83], v30, s[8:11], s55 offen offset:0 sc1
buffer_load_dwordx4 v[84:87], v30, s[8:11], s55 offen offset:256 sc1
buffer_load_dwordx4 v[88:91], v30, s[8:11], s56 offen offset:0 sc1
buffer_load_dwordx4 v[92:95], v30, s[8:11], s56 offen offset:256 sc1
s_waitcnt vmcnt(8)
ds_read_b128 a[32:35], v118 offset:0
ds_read_b128 a[36:39], v119 offset:0
ds_read_b128 a[40:43], v120 offset:0
ds_read_b128 a[44:47], v121 offset:0
s_waitcnt lgkmcnt(0)
s_add_u32 s91, s52, 0
s_add_u32 m0, s53, 0
s_nop 0
buffer_load_dwordx4 v116, s[16:19], s91 offen offset:0 nt lds
s_waitcnt vmcnt(8)
buffer_load_dwordx4 v116, s[16:19], s91 offen offset:1024 nt lds
s_waitcnt vmcnt(8)
buffer_load_dwordx4 v116, s[16:19], s91 offen offset:2048 nt lds
s_waitcnt vmcnt(8)
buffer_load_dwordx4 v116, s[16:19], s91 offen offset:3072 nt lds
s_waitcnt vmcnt(8)
ds_read_b128 a[48:51], v118 offset:4096
ds_read_b128 a[52:55], v119 offset:4096
ds_read_b128 a[56:59], v120 offset:4096
ds_read_b128 a[60:63], v121 offset:4096
s_waitcnt lgkmcnt(0)
s_add_u32 s91, s52, 32768
s_add_u32 m0, s53, 4096
s_nop 0
buffer_load_dwordx4 v116, s[16:19], s91 offen offset:0 nt lds
s_waitcnt vmcnt(5)
v_xor_b32 v30, s100, v82
v_xor_b32 v31, s100, v86
v_or_b32 v30, v30, v31
v_xor_b32 v31, s100, v90
v_or_b32 v30, v30, v31
v_xor_b32 v31, s100, v94
v_or_b32 v30, v30, v31
v_cmp_ne_u32 vcc, 0, v30
s_cbranch_vccnz L_nq_7
v_mfma_f32_16x16x16_bf16 v[96:99], v[32:33], v[80:81], 0
v_mfma_f32_16x16x16_bf16 v[96:99], v[34:35], v[84:85], v[96:99]
v_mfma_f32_16x16x16_bf16 v[96:99], v[32:33], v[88:89], v[96:99]
v_mfma_f32_16x16x16_bf16 v[96:99], v[34:35], v[92:93], v[96:99]
v_xor_b32 v30, s64, v83
v_xor_b32 v31, s64, v87
v_or_b32 v30, v30, v31
v_xor_b32 v31, s64, v91
v_or_b32 v30, v30, v31
v_xor_b32 v31, s64, v95
v_or_b32 v30, v30, v31
v_cmp_ne_u32 vcc, 0, v30
s_nop 0
s_cmp_eq_u64 vcc, 0
s_cselect_b32 s62, 1, 2
v_cvt_pk_bf16_f32 v96, v96, v97
ds_write_b32 v9, v96
L_nq_7:
s_branch L_jn_6
L_noq_5:
s_waitcnt vmcnt(4)
ds_read_b128 a[32:35], v118 offset:0
ds_read_b128 a[36:39], v119 offset:0
ds_read_b128 a[40:43], v120 offset:0
ds_read_b128 a[44:47], v121 offset:0
s_waitcnt lgkmcnt(0)
s_add_u32 s91, s52, 0
s_add_u32 m0, s53, 0
s_nop 0
buffer_load_dwordx4 v116, s[16:19], s91 offen offset:0 nt lds
s_waitcnt vmcnt(4)
buffer_load_dwordx4 v116, s[16:19], s91 offen offset:1024 nt lds
s_waitcnt vmcnt(4)
buffer_load_dwordx4 v116, s[16:19], s91 offen offset:2048 nt lds
s_waitcnt vmcnt(4)
buffer_load_dwordx4 v116, s[16:19], s91 offen offset:3072 nt lds
s_waitcnt vmcnt(4)
ds_read_b128 a[48:51], v118 offset:4096
ds_read_b128 a[52:55], v119 offset:4096
ds_read_b128 a[56:59], v120 offset:4096
ds_read_b128 a[60:63], v121 offset:4096
s_waitcnt lgkmcnt(0)
s_add_u32 s91, s52, 32768
s_add_u32 m0, s53, 4096
s_nop 0
buffer_load_dwordx4 v116, s[16:19], s91 offen offset:0 nt lds
L_jn_6:
s_cmp_lg_u32 s62, 0
s_cbranch_scc1 L_noq_8
v_and_b32 v31, 0xf0, v7
v_lshlrev_b32 v30, 1, v7
v_sub_u32 v30, v30, v31
s_mov_b32 s55, s101
s_add_u32 s56, s55, 8192
buffer_load_dwordx4 v[80:83], v30, s[8:11], s55 offen offset:0 sc1
buffer_load_dwordx4 v[84:87], v30, s[8:11], s55 offen offset:256 sc1
buffer_load_dwordx4 v[88:91], v30, s[8:11], s56 offen offset:0 sc1
buffer_load_dwordx4 v[92:95], v30, s[8:11], s56 offen offset:256 sc1
s_waitcnt vmcnt(8)
s_waitcnt lgkmcnt(0)
ds_read_b64_tr_b16 a[64:65], v122 offset:0
ds_read_b64_tr_b16 a[66:67], v123 offset:0
buffer_load_dwordx4 v116, s[16:19], s91 offen offset:1024 nt lds
s_waitcnt vmcnt(8)
s_waitcnt lgkmcnt(0)
ds_read_b64_tr_b16 a[68:69], v122 offset:1024
ds_read_b64_tr_b16 a[70:71], v123 offset:1024
buffer_load_dwordx4 v116, s[16:19], s91 offen offset:2048 nt lds
s_waitcnt vmcnt(8)
s_waitcnt lgkmcnt(0)
ds_read_b64_tr_b16 a[72:73], v122 offset:2048
ds_read_b64_tr_b16 a[74:75], v123 offset:2048
buffer_load_dwordx4 v116, s[16:19], s91 offen offset:3072 nt lds
s_add_u32 s91, s52, 65536
s_add_u32 m0, s53, 0
s_nop 0
buffer_load_dwordx4 v116, s[16:19], s91 offen offset:0 nt lds
v_and_b32 v31, 0xf0, v7
v_lshlrev_b32 v30, 1, v7
v_sub_u32 v30, v30, v31
s_lshl_b32 s55, s4, 14
s_add_u32 s55, s55, 2883584
s_add_u32 s56, s55, 8192
buffer_load_dwordx4 v[48:51], v30, s[8:11], s55 offen offset:0 sc1
buffer_load_dwordx4 v[52:55], v30, s[8:11], s55 offen offset:256 sc1
buffer_load_dwordx4 v[56:59], v30, s[8:11], s56 offen offset:0 sc1
buffer_load_dwordx4 v[60:63], v30, s[8:11], s56 offen offset:256 sc1
buffer_load_dwordx4 v116, s[16:19], s91 offen offset:1024 nt lds
s_waitcnt vmcnt(9)
v_xor_b32 v30, s100, v82
v_xor_b32 v31, s100, v86
v_or_b32 v30, v30, v31
v_xor_b32 v31, s100, v90
v_or_b32 v30, v30, v31
v_xor_b32 v31, s100, v94
v_or_b32 v30, v30, v31
v_cmp_ne_u32 vcc, 0, v30
s_cbranch_vccnz L_nq_10
v_mfma_f32_16x16x16_bf16 v[96:99], v[32:33], v[80:81], 0
v_mfma_f32_16x16x16_bf16 v[96:99], v[34:35], v[84:85], v[96:99]
v_mfma_f32_16x16x16_bf16 v[96:99], v[32:33], v[88:89], v[96:99]
v_mfma_f32_16x16x16_bf16 v[96:99], v[34:35], v[92:93], v[96:99]
v_xor_b32 v30, s64, v83
v_xor_b32 v31, s64, v87
v_or_b32 v30, v30, v31
v_xor_b32 v31, s64, v91
v_or_b32 v30, v30, v31
v_xor_b32 v31, s64, v95
v_or_b32 v30, v30, v31
v_cmp_ne_u32 vcc, 0, v30
s_nop 0
s_cmp_eq_u64 vcc, 0
s_cselect_b32 s62, 1, 2
v_cvt_pk_bf16_f32 v96, v96, v97
ds_write_b32 v9, v96
L_nq_10:
s_branch L_jn_9
L_noq_8:
s_waitcnt vmcnt(4)
s_waitcnt lgkmcnt(0)
ds_read_b64_tr_b16 a[64:65], v122 offset:0
ds_read_b64_tr_b16 a[66:67], v123 offset:0
buffer_load_dwordx4 v116, s[16:19], s91 offen offset:1024 nt lds
s_waitcnt vmcnt(4)
s_waitcnt lgkmcnt(0)
ds_read_b64_tr_b16 a[68:69], v122 offset:1024
ds_read_b64_tr_b16 a[70:71], v123 offset:1024
buffer_load_dwordx4 v116, s[16:19], s91 offen offset:2048 nt lds
s_waitcnt vmcnt(4)
s_waitcnt lgkmcnt(0)
ds_read_b64_tr_b16 a[72:73], v122 offset:2048
ds_read_b64_tr_b16 a[74:75], v123 offset:2048
buffer_load_dwordx4 v116, s[16:19], s91 offen offset:3072 nt lds
s_add_u32 s91, s52, 65536
s_add_u32 m0, s53, 0
s_nop 0
buffer_load_dwordx4 v116, s[16:19], s91 offen offset:0 nt lds
v_and_b32 v31, 0xf0, v7
v_lshlrev_b32 v30, 1, v7
v_sub_u32 v30, v30, v31
s_lshl_b32 s55, s4, 14
s_add_u32 s55, s55, 2883584
s_add_u32 s56, s55, 8192
buffer_load_dwordx4 v[48:51], v30, s[8:11], s55 offen offset:0 sc1
buffer_load_dwordx4 v[52:55], v30, s[8:11], s55 offen offset:256 sc1
buffer_load_dwordx4 v[56:59], v30, s[8:11], s56 offen offset:0 sc1
buffer_load_dwordx4 v[60:63], v30, s[8:11], s56 offen offset:256 sc1
buffer_load_dwordx4 v116, s[16:19], s91 offen offset:1024 nt lds
L_jn_9:
s_lshl_b32 s55, s3, 2
s_add_u32 s55, s55, 127424
v_mov_b32 v30, s55
v_mov_b32 v31, s62
ds_write_b32 v30, v31
s_branch L_sj_3
L_shi_2:
s_waitcnt vmcnt(4)
ds_read_b128 a[0:3], v118 offset:0
ds_read_b128 a[4:7], v119 offset:0
ds_read_b128 a[8:11], v120 offset:0
ds_read_b128 a[12:15], v121 offset:0
s_waitcnt lgkmcnt(0)
s_add_u32 s91, s52, 65536
s_add_u32 m0, s53, 0
s_nop 0
buffer_load_dwordx4 v116, s[12:15], s91 offen offset:0 nt lds
buffer_load_dwordx4 v116, s[12:15], s91 offen offset:1024 nt lds
buffer_load_dwordx4 v116, s[12:15], s91 offen offset:2048 nt lds
buffer_load_dwordx4 v116, s[12:15], s91 offen offset:3072 nt lds
s_waitcnt vmcnt(4)
ds_read_b128 a[16:19], v118 offset:4096
ds_read_b128 a[20:23], v119 offset:4096
ds_read_b128 a[24:27], v120 offset:4096
ds_read_b128 a[28:31], v121 offset:4096
s_waitcnt lgkmcnt(0)
s_add_u32 s91, s52, 98304
s_add_u32 m0, s53, 4096
s_nop 0
buffer_load_dwordx4 v116, s[12:15], s91 offen offset:0 nt lds
s_waitcnt vmcnt(4)
buffer_load_dwordx4 v116, s[12:15], s91 offen offset:1024 nt lds
s_waitcnt vmcnt(4)
buffer_load_dwordx4 v116, s[12:15], s91 offen offset:2048 nt lds
s_waitcnt vmcnt(4)
buffer_load_dwordx4 v116, s[12:15], s91 offen offset:3072 nt lds
s_waitcnt vmcnt(4)
ds_read_b128 a[32:35], v118 offset:0
ds_read_b128 a[36:39], v119 offset:0
ds_read_b128 a[40:43], v120 offset:0
ds_read_b128 a[44:47], v121 offset:0
s_waitcnt lgkmcnt(0)
s_add_u32 s91, s52, 0
s_add_u32 m0, s53, 0
s_nop 0
buffer_load_dwordx4 v116, s[16:19], s91 offen offset:0 nt lds
s_waitcnt vmcnt(4)
buffer_load_dwordx4 v116, s[16:19], s91 offen offset:1024 nt lds
s_waitcnt vmcnt(4)
buffer_load_dwordx4 v116, s[16:19], s91 offen offset:2048 nt lds
s_waitcnt vmcnt(4)
buffer_load_dwordx4 v116, s[16:19], s91 offen offset:3072 nt lds
s_waitcnt vmcnt(4)
ds_read_b128 a[48:51], v118 offset:4096
ds_read_b128 a[52:55], v119 offset:4096
ds_read_b128 a[56:59], v120 offset:4096
ds_read_b128 a[60:63], v121 offset:4096
s_waitcnt lgkmcnt(0)
s_add_u32 s91, s52, 32768
s_add_u32 m0, s53, 4096
s_nop 0
buffer_load_dwordx4 v116, s[16:19], s91 offen offset:0 nt lds
s_waitcnt vmcnt(4)
s_waitcnt lgkmcnt(0)
ds_read_b64_tr_b16 a[64:65], v122 offset:0
ds_read_b64_tr_b16 a[66:67], v123 offset:0
buffer_load_dwordx4 v116, s[16:19], s91 offen offset:1024 nt lds
s_waitcnt vmcnt(4)
s_waitcnt lgkmcnt(0)
ds_read_b64_tr_b16 a[68:69], v122 offset:1024
ds_read_b64_tr_b16 a[70:71], v123 offset:1024
buffer_load_dwordx4 v116, s[16:19], s91 offen offset:2048 nt lds
s_waitcnt vmcnt(4)
s_waitcnt lgkmcnt(0)
ds_read_b64_tr_b16 a[72:73], v122 offset:2048
ds_read_b64_tr_b16 a[74:75], v123 offset:2048
buffer_load_dwordx4 v116, s[16:19], s91 offen offset:3072 nt lds
s_add_u32 s91, s52, 65536
s_add_u32 m0, s53, 0
s_nop 0
buffer_load_dwordx4 v116, s[16:19], s91 offen offset:0 nt lds
buffer_load_dwordx4 v116, s[16:19], s91 offen offset:1024 nt lds
L_sj_3:
s_waitcnt lgkmcnt(0)
s_barrier
v_mov_b32 v30, 127424
ds_read_b128 v[72:75], v30
s_waitcnt lgkmcnt(0)
v_xor_b32 v30, 1, v72
v_xor_b32 v31, 1, v73
v_or_b32 v30, v30, v31
v_xor_b32 v31, 1, v74
v_or_b32 v30, v30, v31
v_xor_b32 v31, 1, v75
v_or_b32 v30, v30, v31
v_cmp_ne_u32 vcc, 0, v30
s_nop 0
s_cmp_eq_u64 vcc, 0
s_cbranch_scc1 L_okq_11
s_cmp_ge_u32 s3, 4
s_cbranch_scc1 L_hi_12
buffer_store_dwordx4 v[100:103], v109, s[8:11], 0 offen sc1
buffer_store_dwordx4 v[104:107], v109, s[8:11], 0 offen offset:256 sc1
s_cmp_lg_u32 s62, 0
s_cbranch_scc1 L_qdone_13
L_rq_14:
v_and_b32 v31, 0xf0, v7
v_lshlrev_b32 v30, 1, v7
v_sub_u32 v30, v30, v31
s_mov_b32 s55, s101
s_add_u32 s56, s55, 8192
buffer_load_dwordx4 v[80:83], v30, s[8:11], s55 offen offset:0 sc1
buffer_load_dwordx4 v[84:87], v30, s[8:11], s55 offen offset:256 sc1
buffer_load_dwordx4 v[88:91], v30, s[8:11], s56 offen offset:0 sc1
buffer_load_dwordx4 v[92:95], v30, s[8:11], s56 offen offset:256 sc1
s_waitcnt vmcnt(0)
v_xor_b32 v30, s100, v82
v_xor_b32 v31, s100, v86
v_or_b32 v30, v30, v31
v_xor_b32 v31, s100, v90
v_or_b32 v30, v30, v31
v_xor_b32 v31, s100, v94
v_or_b32 v30, v30, v31
v_cmp_ne_u32 vcc, 0, v30
s_cbranch_vccz L_gq_15
s_sub_u32 s59, s59, 1
s_cbranch_scc0 L_rq_14
s_mov_b32 s59, 0
L_gq_15:
v_mfma_f32_16x16x16_bf16 v[96:99], v[32:33], v[80:81], 0
v_mfma_f32_16x16x16_bf16 v[96:99], v[34:35], v[84:85], v[96:99]
v_mfma_f32_16x16x16_bf16 v[96:99], v[32:33], v[88:89], v[96:99]
v_mfma_f32_16x16x16_bf16 v[96:99], v[34:35], v[92:93], v[96:99]
v_xor_b32 v30, s64, v83
v_xor_b32 v31, s64, v87
v_or_b32 v30, v30, v31
v_xor_b32 v31, s64, v91
v_or_b32 v30, v30, v31
v_xor_b32 v31, s64, v95
v_or_b32 v30, v30, v31
v_cmp_ne_u32 vcc, 0, v30
s_nop 0
s_cmp_eq_u64 vcc, 0
s_cselect_b32 s62, 1, 2
v_cvt_pk_bf16_f32 v96, v96, v97
ds_write_b32 v9, v96
L_qdone_13:
L_hi_12:
s_barrier
s_cmp_ge_u32 s3, 4
s_cbranch_scc1 L_hi_16
s_lshl_b32 s55, s3, 2
s_add_u32 s55, s55, 127424
v_mov_b32 v30, s55
v_mov_b32 v31, s62
ds_write_b32 v30, v31
L_hi_16:
s_waitcnt lgkmcnt(0)
s_barrier
v_mov_b32 v30, 127424
ds_read_b128 v[72:75], v30
s_waitcnt lgkmcnt(0)
v_xor_b32 v30, 1, v72
v_xor_b32 v31, 1, v73
v_or_b32 v30, v30, v31
v_xor_b32 v31, 1, v74
v_or_b32 v30, v30, v31
v_xor_b32 v31, 1, v75
v_or_b32 v30, v30, v31
v_cmp_ne_u32 vcc, 0, v30
s_nop 0
s_cmp_eq_u64 vcc, 0
L_okq_11:
s_cselect_b32 s60, 1, 0
v_mov_b32 v118, v110
v_mov_b32 v114, 0
s_mov_b32 s80, 0
s_mov_b32 s81, 0
s_mov_b32 s82, 0
s_mov_b32 s83, 0
s_mov_b32 s84, 0
s_mov_b32 s85, 0
s_mul_i32 s55, s5, 1312
s_add_u32 s55, s55, s73
s_add_u32 s55, s55, 60416
s_sub_u32 s56, s77, 7168
v_add_u32 v119, s55, v115
v_add_u32 v120, s56, v115
v_add_u32 v30, 130560, v120
v_cmp_lt_u32 vcc, 31, v0
s_nop 1
v_cndmask_b32 v120, v120, v30, vcc
v_add_u32 v121, 1024, v119
v_mov_b32 v30, 2147418112
v_cmp_lt_u32 vcc, 17, v0
s_nop 1
v_cndmask_b32 v121, v121, v30, vcc
v_cmp_gt_u32 vcc, 7168, v115
s_nop 1
v_cndmask_b32 v119, v119, v30, vcc
v_cndmask_b32 v120, v120, v30, vcc
v_cndmask_b32 v121, v121, v30, vcc
s_branch L_scores
L_scored:
v_mfma_f32_4x4x4_16b_bf16 v[96:99], v[86:87], a[64:65], 0 cbsz:4 abid:0
v_mfma_f32_4x4x4_16b_bf16 v[100:103], v[86:87], a[66:67], 0 cbsz:4 abid:0
v_mfma_f32_4x4x4_16b_bf16 v[104:107], v[86:87], a[68:69], 0 cbsz:4 abid:4
v_mfma_f32_4x4x4_16b_bf16 v[108:111], v[86:87], a[70:71], 0 cbsz:4 abid:4
v_mfma_f32_4x4x4_16b_bf16 v[96:99], v[86:87], a[72:73], v[96:99] cbsz:4 abid:8
v_mfma_f32_4x4x4_16b_bf16 v[100:103], v[86:87], a[74:75], v[100:103] cbsz:4 abid:8
v_add_f32_dpp v85, v88, v88 row_ror:4 row_mask:0xf bank_mask:0xf
s_nop 1
v_add_f32_dpp v85, v85, v85 row_ror:8 row_mask:0xf bank_mask:0xf
s_mov_b64 exec, 15
ds_write_b64 v18, v[84:85]
s_mov_b64 exec, -1
s_waitcnt vmcnt(6)
ds_read_b64_tr_b16 a[76:77], v122 offset:3072
ds_read_b64_tr_b16 a[78:79], v123 offset:3072
s_add_u32 s91, s52, 65536
s_add_u32 m0, s53, 0
s_nop 0
buffer_load_dwordx4 v116, s[16:19], s91 offen offset:2048 nt lds
s_waitcnt vmcnt(6)
s_waitcnt lgkmcnt(0)
ds_read_b64_tr_b16 a[80:81], v122 offset:4096
ds_read_b64_tr_b16 a[82:83], v123 offset:4096
v_mfma_f32_4x4x4_16b_bf16 v[104:107], v[86:87], a[76:77], v[104:107] cbsz:4 abid:12
v_mfma_f32_4x4x4_16b_bf16 v[108:111], v[86:87], a[78:79], v[108:111] cbsz:4 abid:12
buffer_load_dwordx4 v116, s[16:19], s91 offen offset:3072 nt lds
s_waitcnt vmcnt(6)
s_waitcnt lgkmcnt(0)
ds_read_b64_tr_b16 a[84:85], v122 offset:5120
ds_read_b64_tr_b16 a[86:87], v123 offset:5120
v_mfma_f32_4x4x4_16b_bf16 v[96:99], v[86:87], a[80:81], v[96:99] cbsz:4 abid:1
v_mfma_f32_4x4x4_16b_bf16 v[100:103], v[86:87], a[82:83], v[100:103] cbsz:4 abid:1
s_add_u32 s91, s52, 98304
s_add_u32 m0, s53, 4096
s_nop 0
buffer_load_dwordx4 v116, s[16:19], s91 offen offset:0 nt lds
s_waitcnt vmcnt(6)
s_waitcnt lgkmcnt(0)
ds_read_b64_tr_b16 a[88:89], v122 offset:6144
ds_read_b64_tr_b16 a[90:91], v123 offset:6144
v_mfma_f32_4x4x4_16b_bf16 v[104:107], v[86:87], a[84:85], v[104:107] cbsz:4 abid:5
v_mfma_f32_4x4x4_16b_bf16 v[108:111], v[86:87], a[86:87], v[108:111] cbsz:4 abid:5
buffer_load_dwordx4 v116, s[16:19], s91 offen offset:1024 nt lds
s_waitcnt vmcnt(6)
s_waitcnt lgkmcnt(0)
ds_read_b64_tr_b16 a[92:93], v122 offset:7168
ds_read_b64_tr_b16 a[94:95], v123 offset:7168
v_mfma_f32_4x4x4_16b_bf16 v[96:99], v[86:87], a[88:89], v[96:99] cbsz:4 abid:9
v_mfma_f32_4x4x4_16b_bf16 v[100:103], v[86:87], a[90:91], v[100:103] cbsz:4 abid:9
buffer_load_dwordx4 v116, s[16:19], s91 offen offset:2048 nt lds
s_waitcnt vmcnt(6)
s_waitcnt lgkmcnt(0)
ds_read_b64_tr_b16 a[96:97], v122 offset:0
ds_read_b64_tr_b16 a[98:99], v123 offset:0
v_mfma_f32_4x4x4_16b_bf16 v[104:107], v[86:87], a[92:93], v[104:107] cbsz:4 abid:13
v_mfma_f32_4x4x4_16b_bf16 v[108:111], v[86:87], a[94:95], v[108:111] cbsz:4 abid:13
buffer_load_dwordx4 v116, s[16:19], s91 offen offset:3072 nt lds
s_waitcnt vmcnt(6)
s_waitcnt lgkmcnt(0)
ds_read_b64_tr_b16 a[100:101], v122 offset:1024
ds_read_b64_tr_b16 a[102:103], v123 offset:1024
v_mfma_f32_4x4x4_16b_bf16 v[96:99], v[86:87], a[96:97], v[96:99] cbsz:4 abid:2
v_mfma_f32_4x4x4_16b_bf16 v[100:103], v[86:87], a[98:99], v[100:103] cbsz:4 abid:2
s_cmp_ge_u32 s3, 4
s_cbranch_scc1 L_hi_17
v_xor_b32 v30, s100, v50
v_xor_b32 v31, s100, v54
v_or_b32 v30, v30, v31
v_xor_b32 v31, s100, v58
v_or_b32 v30, v30, v31
v_xor_b32 v31, s100, v62
v_or_b32 v30, v30, v31
v_cmp_ne_u32 vcc, 0, v30
s_cbranch_vccz L_cq_18
L_rq_19:
v_and_b32 v31, 0xf0, v7
v_lshlrev_b32 v30, 1, v7
v_sub_u32 v30, v30, v31
s_lshl_b32 s55, s4, 14
s_add_u32 s55, s55, 2883584
s_add_u32 s56, s55, 8192
buffer_load_dwordx4 v[48:51], v30, s[8:11], s55 offen offset:0 sc1
buffer_load_dwordx4 v[52:55], v30, s[8:11], s55 offen offset:256 sc1
buffer_load_dwordx4 v[56:59], v30, s[8:11], s56 offen offset:0 sc1
buffer_load_dwordx4 v[60:63], v30, s[8:11], s56 offen offset:256 sc1
s_waitcnt vmcnt(0)
v_xor_b32 v30, s100, v50
v_xor_b32 v31, s100, v54
v_or_b32 v30, v30, v31
v_xor_b32 v31, s100, v58
v_or_b32 v30, v30, v31
v_xor_b32 v31, s100, v62
v_or_b32 v30, v30, v31
v_cmp_ne_u32 vcc, 0, v30
s_cbranch_vccz L_gq_20
s_sub_u32 s59, s59, 1
s_cbranch_scc0 L_rq_19
s_mov_b32 s59, 0
L_gq_20:
L_cq_18:
v_mfma_f32_16x16x16_bf16 v[64:67], v[32:33], v[48:49], 0
v_mfma_f32_16x16x16_bf16 v[64:67], v[34:35], v[52:53], v[64:67]
v_mfma_f32_16x16x16_bf16 v[64:67], v[32:33], v[56:57], v[64:67]
v_mfma_f32_16x16x16_bf16 v[64:67], v[34:35], v[60:61], v[64:67]
s_mov_b32 s56, 0x3b000000
s_nop 6
v_pk_mul_f32 v[24:25], v[64:65], s[56:57] op_sel_hi:[1,0]
L_hi_17:
s_waitcnt vmcnt(5)
s_waitcnt lgkmcnt(0)
ds_read_b64_tr_b16 a[104:105], v122 offset:2048
ds_read_b64_tr_b16 a[106:107], v123 offset:2048
v_mfma_f32_4x4x4_16b_bf16 v[104:107], v[86:87], a[100:101], v[104:107] cbsz:4 abid:6
v_mfma_f32_4x4x4_16b_bf16 v[108:111], v[86:87], a[102:103], v[108:111] cbsz:4 abid:6
s_waitcnt vmcnt(4)
s_waitcnt lgkmcnt(0)
ds_read_b64_tr_b16 a[108:109], v122 offset:3072
ds_read_b64_tr_b16 a[110:111], v123 offset:3072
v_mfma_f32_4x4x4_16b_bf16 v[96:99], v[86:87], a[104:105], v[96:99] cbsz:4 abid:10
v_mfma_f32_4x4x4_16b_bf16 v[100:103], v[86:87], a[106:107], v[100:103] cbsz:4 abid:10
s_waitcnt vmcnt(3)
s_waitcnt lgkmcnt(0)
ds_read_b64_tr_b16 a[112:113], v122 offset:4096
ds_read_b64_tr_b16 a[114:115], v123 offset:4096
v_mfma_f32_4x4x4_16b_bf16 v[104:107], v[86:87], a[108:109], v[104:107] cbsz:4 abid:14
v_mfma_f32_4x4x4_16b_bf16 v[108:111], v[86:87], a[110:111], v[108:111] cbsz:4 abid:14
s_waitcnt vmcnt(2)
s_waitcnt lgkmcnt(0)
ds_read_b64_tr_b16 a[116:117], v122 offset:5120
ds_read_b64_tr_b16 a[118:119], v123 offset:5120
v_mfma_f32_4x4x4_16b_bf16 v[96:99], v[86:87], a[112:113], v[96:99] cbsz:4 abid:3
v_mfma_f32_4x4x4_16b_bf16 v[100:103], v[86:87], a[114:115], v[100:103] cbsz:4 abid:3
v_mov_b32 v92, -1
v_mov_b32 v93, -1
v_mov_b32 v94, -1
v_mov_b32 v95, -1
buffer_store_dwordx4 v[92:95], v119, s[8:11], 0 offen sc1
buffer_store_dwordx4 v[92:95], v120, s[8:11], 0 offen sc1
buffer_store_dwordx4 v[92:95], v121, s[8:11], 0 offen sc1
s_lshl_b32 s55, s4, 9
s_lshl_b32 s56, s6, 7
s_add_u32 s55, s55, s56
s_lshl_b32 s56, s3, 4
s_add_u32 s55, s55, s56
s_lshl_b32 s55, s55, 10
s_lshl_b32 s56, s7, 7
s_add_u32 s55, s55, s56
s_lshl_b32 s56, s3, 11
s_add_u32 m0, s56, 81920
s_nop 0
buffer_load_dwordx4 v124, s[24:27], s55 offen nt lds
s_add_u32 s55, s55, 8192
s_add_u32 m0, m0, 1024
s_nop 0
buffer_load_dwordx4 v124, s[24:27], s55 offen nt lds
s_add_u32 s54, s3, 0
s_lshl_b32 s56, s54, 10
s_add_u32 m0, s56, 98304
s_lshl_b32 s55, s92, 6
s_lshl_b32 s57, s54, 3
s_add_u32 s55, s55, s57
s_lshl_b32 s55, s55, 10
s_lshl_b32 s57, s7, 7
s_add_u32 s55, s55, s57
s_add_u32 m0, s56, 114688
s_nop 0
buffer_load_dwordx4 v127, s[36:39], s55 offen nt lds
s_waitcnt vmcnt(7)
s_waitcnt lgkmcnt(0)
ds_read_b64_tr_b16 a[120:121], v122 offset:6144
ds_read_b64_tr_b16 a[122:123], v123 offset:6144
v_mfma_f32_4x4x4_16b_bf16 v[104:107], v[86:87], a[116:117], v[104:107] cbsz:4 abid:7
v_mfma_f32_4x4x4_16b_bf16 v[108:111], v[86:87], a[118:119], v[108:111] cbsz:4 abid:7
s_waitcnt vmcnt(6)
s_waitcnt lgkmcnt(0)
ds_read_b64_tr_b16 a[124:125], v122 offset:7168
ds_read_b64_tr_b16 a[126:127], v123 offset:7168
v_mfma_f32_4x4x4_16b_bf16 v[96:99], v[86:87], a[120:121], v[96:99] cbsz:4 abid:11
v_mfma_f32_4x4x4_16b_bf16 v[100:103], v[86:87], a[122:123], v[100:103] cbsz:4 abid:11
s_waitcnt lgkmcnt(0)
v_mfma_f32_4x4x4_16b_bf16 v[104:107], v[86:87], a[124:125], v[104:107] cbsz:4 abid:15
v_mfma_f32_4x4x4_16b_bf16 v[108:111], v[86:87], a[126:127], v[108:111] cbsz:4 abid:15
L_merge:
s_nop 3
v_add_f32 v64, v96, v104
v_add_f32 v65, v100, v108
v_add_f32 v66, v97, v105
v_add_f32 v67, v101, v109
ds_write_b128 v16, v[64:67] offset:0
v_add_f32 v68, v98, v106
v_add_f32 v69, v102, v110
v_add_f32 v70, v99, v107
v_add_f32 v71, v103, v111
ds_write_b128 v16, v[68:71] offset:1024
s_cmp_ge_u32 s3, 4
s_cbranch_scc1 L_hi_21
L_rm_22:
ds_read_b64 v[72:73], v19
s_waitcnt lgkmcnt(0)
v_cmp_eq_u32 vcc, -1, v73
s_cbranch_vccnz L_rt_24
L_rd_23:
v_max_f32_dpp v74, v72, v72 quad_perm:[1,0,3,2] row_mask:0xf bank_mask:0xf
s_nop 1
v_max_f32_dpp v74, v74, v74 quad_perm:[2,3,0,1] row_mask:0xf bank_mask:0xf
s_nop 1
v_max_f32_dpp v74, v74, v74 row_half_mirror row_mask:0xf bank_mask:0xf
v_sub_f32 v72, v72, v74
v_exp_f32 v72, v72
s_nop 0
v_mul_f32 v75, v73, v72
v_readlane_b32 s80, v72, 0
v_readlane_b32 s81, v72, 1
v_add_f32_dpp v75, v75, v75 quad_perm:[1,0,3,2] row_mask:0xf bank_mask:0xf
v_readlane_b32 s82, v72, 2
v_readlane_b32 s83, v72, 3
v_add_f32_dpp v75, v75, v75 quad_perm:[2,3,0,1] row_mask:0xf bank_mask:0xf
v_readlane_b32 s84, v72, 4
v_readlane_b32 s85, v72, 5
v_add_f32_dpp v75, v75, v75 row_half_mirror row_mask:0xf bank_mask:0xf
s_cmp_eq_u32 s63, 0
s_cbranch_scc1 L_v0_25
s_cmp_eq_u32 s60, 1
s_cbranch_scc0 L_wt_27
buffer_store_dwordx2 v[74:75], v46, s[8:11], s76 offen
L_sd_28:
L_vj_26:
v_readlane_b32 s86, v72, 6
v_readlane_b32 s87, v72, 7
L_hi_21:
s_cmp_ge_u32 s3, 4
s_waitcnt lgkmcnt(0)
s_barrier
s_cbranch_scc1 L_up_32
ds_read_b64 v[80:81], v17 offset:0
ds_read_b64 v[82:83], v17 offset:8192
ds_read_b64 v[84:85], v17 offset:16384
ds_read_b64 v[86:87], v17 offset:24576
ds_read_b64 v[88:89], v17 offset:32768
ds_read_b64 v[90:91], v17 offset:40960
ds_read_b64 v[92:93], v17 offset:49152
ds_read_b64 v[94:95], v17 offset:57344
s_waitcnt lgkmcnt(6)
v_pk_mul_f32 v[64:65], v[80:81], s[80:81] op_sel_hi:[1,0]
v_pk_mul_f32 v[66:67], v[82:83], s[80:81] op_sel:[0,1]
s_waitcnt lgkmcnt(4)
v_pk_fma_f32 v[64:65], v[84:85], s[82:83], v[64:65] op_sel_hi:[1,0,1]
v_pk_fma_f32 v[66:67], v[86:87], s[82:83], v[66:67] op_sel:[0,1,0]
s_waitcnt lgkmcnt(2)
v_pk_fma_f32 v[64:65], v[88:89], s[84:85], v[64:65] op_sel_hi:[1,0,1]
v_pk_fma_f32 v[66:67], v[90:91], s[84:85], v[66:67] op_sel:[0,1,0]
s_waitcnt lgkmcnt(0)
v_pk_fma_f32 v[64:65], v[92:93], s[86:87], v[64:65] op_sel_hi:[1,0,1]
v_pk_fma_f32 v[66:67], v[94:95], s[86:87], v[66:67] op_sel:[0,1,0]
v_pk_add_f32 v[64:65], v[64:65], v[66:67]
v_cvt_pk_bf16_f32 v64, v64, v65
s_cmp_eq_u32 s63, 0
s_cbranch_scc1 L_v0_33
s_cmp_eq_u32 s60, 1
s_cbranch_scc0 L_wt_35
buffer_store_dword v64, v15, s[8:11], s75 offen
L_sd_36:
L_vj_34:
L_hi_31:
L_layer:
s_cmp_ge_u32 s3, 4
s_cbranch_scc1 L_hi_43
s_cmp_eq_u32 s63, 0
s_cbranch_scc1 L_v0_44
s_waitcnt vmcnt(2)
ds_read_b64_tr_b16 v[48:49], v22 offset:0
ds_read_b64_tr_b16 v[50:51], v22 offset:256
ds_read_b64_tr_b16 v[52:53], v22 offset:2048
ds_read_b64_tr_b16 v[54:55], v22 offset:2304
ds_read_b64_tr_b16 v[56:57], v22 offset:4096
ds_read_b64_tr_b16 v[58:59], v22 offset:4352
ds_read_b64_tr_b16 v[60:61], v22 offset:6144
ds_read_b64_tr_b16 v[62:63], v22 offset:6400
L_retry_46:
buffer_load_dwordx2 v[72:73], v29, s[8:11], s70 offen sc1
buffer_load_dwordx2 v[74:75], v29, s[8:11], s70 offen offset:32 sc1
s_waitcnt vmcnt(0)
v_max3_u32 v30, v72, v73, v74
v_max_u32 v30, v30, v75
v_cmp_eq_u32 vcc, -1, v30
s_cbranch_vccnz L_again_48
L_got_47:
buffer_load_dwordx4 v[100:103], v7, s[8:11], s67 offen sc1
s_add_u32 s55, s67, 4096
buffer_load_dwordx4 v[104:107], v7, s[8:11], s55 offen sc1
v_max_f32 v76, v72, v74
v_mov_b32 v77, v76
s_nop 1
v_permlane16_swap_b32 v76, v77
v_max_f32 v76, v76, v77
v_mov_b32 v77, v76
s_nop 1
v_permlane32_swap_b32 v76, v77
v_max_f32 v76, v76, v77
v_sub_f32 v72, v72, v76
v_sub_f32 v74, v74, v76
v_exp_f32 v72, v72
v_exp_f32 v74, v74
v_cvt_pk_bf16_f32 v72, v72, v72
v_cvt_pk_bf16_f32 v74, v74, v74
v_and_b32 v80, v36, v72
v_and_b32 v81, v37, v72
v_and_b32 v82, v38, v72
v_and_b32 v83, v39, v72
v_and_b32 v84, v36, v74
v_and_b32 v85, v37, v74
v_and_b32 v86, v38, v74
v_and_b32 v87, v39, v74
v_and_b32 v72, 0xffff0000, v72
v_and_b32 v74, 0xffff0000, v74
v_mul_f32 v79, v73, v72
v_fmac_f32 v79, v75, v74
v_mov_b32 v77, v79
s_nop 1
v_permlane16_swap_b32 v79, v77
v_add_f32 v79, v79, v77
v_mov_b32 v77, v79
s_nop 1
v_permlane32_swap_b32 v79, v77
v_add_f32 v79, v79, v77
v_rcp_f32 v78, v79
buffer_load_dwordx4 v[116:119], v7, s[8:11], s67 offen sc1
s_add_u32 s55, s67, 4096
buffer_load_dwordx4 v[120:123], v7, s[8:11], s55 offen sc1
L_seta_51:
s_waitcnt vmcnt(2)
v_mfma_f32_16x16x32_bf16 v[96:99], v[80:83], v[100:103], 0
v_mfma_f32_16x16x32_bf16 v[96:99], v[84:87], v[104:107], v[96:99]
v_max3_u32 v30, v100, v101, v102
v_max3_u32 v31, v103, v104, v105
v_max3_u32 v30, v30, v106, v107
v_max_u32 v30, v30, v31
v_cmp_eq_u32 vcc, -1, v30
s_cbranch_vccnz L_setb_50
L_got_49:
L_vj_45:
s_nop 1
v_pk_mul_f32 v[96:97], v[96:97], v[78:79] op_sel_hi:[1,0]
v_cvt_pk_bf16_f32 v96, v96, v97
ds_write_b32 v9, v96 offset:1280
L_hi_43:
s_cmp_ge_u32 s3, 4
s_waitcnt lgkmcnt(0)
s_barrier
s_cbranch_scc1 L_sk_56
ds_read_b128 v[64:67], v10 offset:1280
ds_read_b128 v[68:71], v10 offset:1344
ds_read_b128 v[72:75], v10 offset:1408
ds_read_b128 v[76:79], v10 offset:1472
s_cmp_eq_u32 s63, 0
s_cbranch_scc1 L_v0_58
s_waitcnt lgkmcnt(3)
v_mfma_f32_16x16x32_bf16 v[96:99], v[48:51], v[64:67], 0
s_waitcnt lgkmcnt(2)
v_mfma_f32_16x16x32_bf16 v[96:99], v[52:55], v[68:71], v[96:99]
s_waitcnt lgkmcnt(1)
v_mfma_f32_16x16x32_bf16 v[96:99], v[56:59], v[72:75], v[96:99]
s_waitcnt lgkmcnt(0)
v_mfma_f32_16x16x32_bf16 v[96:99], v[60:63], v[76:79], v[96:99]
s_add_u32 s55, s77, 0
s_nop 6
v_cvt_pk_bf16_f32 v96, v96, v97
v_cvt_pk_bf16_f32 v97, v98, v99
buffer_store_dwordx2 v[96:97], v8, s[8:11], s55 offen sc1
L_vj_59:
s_cmp_eq_u32 s63, 0
s_cbranch_scc1 L_aw_61_lo
ds_read_b64_tr_b16 v[48:49], v21 offset:0
ds_read_b64_tr_b16 v[50:51], v21 offset:512
ds_read_b64_tr_b16 v[52:53], v21 offset:4096
ds_read_b64_tr_b16 v[54:55], v21 offset:4608
ds_read_b64_tr_b16 v[56:57], v21 offset:8192
ds_read_b64_tr_b16 v[58:59], v21 offset:8704
ds_read_b64_tr_b16 v[60:61], v21 offset:12288
ds_read_b64_tr_b16 v[62:63], v21 offset:12800
s_sleep 12
s_branch L_dl_57
L_sk_56:
s_cmp_eq_u32 s63, 0
s_cbranch_scc1 L_aw_61_hi
s_sleep 18
L_dl_57:
L_go_60:
s_add_u32 s54, s72, 0
L_retry_69:
buffer_load_dwordx4 v[64:67], v3, s[8:11], s54 offen sc1
s_add_u32 s55, s54, 8192
buffer_load_dwordx4 v[68:71], v3, s[8:11], s55 offen sc1
s_waitcnt vmcnt(0)
L_xa_landed:
v_mfma_f32_16x16x32_bf16 v[96:99], v[32:35], v[64:67], 0
v_mfma_f32_16x16x32_bf16 v[96:99], v[32:35], v[68:71], v[96:99]
v_max3_u32 v30, v64, v65, v66
v_max3_u32 v31, v67, v68, v69
v_max3_u32 v30, v30, v70, v71
v_max_u32 v30, v30, v31
v_cmp_eq_u32 vcc, -1, v30
s_cbranch_vccnz L_again_71
L_got_70:
s_nop 1
v_add_f32_dpp v96, v96, v96 row_ror:4 row_mask:0xf bank_mask:0xf
v_add_f32_dpp v97, v97, v97 row_ror:4 row_mask:0xf bank_mask:0xf
s_nop 0
v_add_f32_dpp v96, v96, v96 row_ror:8 row_mask:0xf bank_mask:0xf
v_add_f32_dpp v97, v97, v97 row_ror:8 row_mask:0xf bank_mask:0xf
v_pk_add_f32 v[112:113], v[112:113], v[96:97]
v_cvt_pk_bf16_f32 v96, v112, v113
ds_write_b32 v14, v96
s_cmp_ge_u32 s3, 4
s_waitcnt lgkmcnt(0)
s_barrier
s_cbranch_scc1 L_up_73
ds_read_b128 v[80:83], v13
ds_read_b128 v[84:87], v13 offset:64
s_cmp_eq_u32 s63, 0
s_cbranch_scc1 L_fo_74
L_bk_75:
s_waitcnt lgkmcnt(0)
v_mfma_f32_16x16x32_bf16 v[96:99], v[48:51], v[80:83], 0
v_mfma_f32_16x16x32_bf16 v[104:107], v[56:59], v[80:83], 0
v_mfma_f32_16x16x32_bf16 v[96:99], v[52:55], v[84:87], v[96:99]
v_mfma_f32_16x16x32_bf16 v[104:107], v[60:63], v[84:87], v[104:107]
s_cmp_eq_u32 s60, 1
s_nop 5
v_cvt_pk_bf16_f32 v96, v96, v97
v_cvt_pk_bf16_f32 v97, v98, v99
v_cvt_pk_bf16_f32 v98, v104, v105
v_cvt_pk_bf16_f32 v99, v106, v107
s_cbranch_scc0 L_wt_76
buffer_store_dwordx4 v[96:99], v5, s[8:11], s58 offen
L_sd_77:
ds_read_b64_tr_b16 v[48:49], v21 offset:16384
ds_read_b64_tr_b16 v[50:51], v21 offset:16896
ds_read_b64_tr_b16 v[52:53], v21 offset:20480
ds_read_b64_tr_b16 v[54:55], v21 offset:20992
s_cmp_eq_u32 s63, 0
s_cbranch_scc1 L_v0_78
buffer_load_dwordx4 v[80:83], v7, s[8:11], s68 offen sc1
s_add_u32 s55, s68, 4096
buffer_load_dwordx4 v[84:87], v7, s[8:11], s55 offen sc1
buffer_load_dwordx2 v[88:89], v2, s[8:11], s71 offen sc1
s_sleep 3
buffer_load_dwordx4 v[100:103], v7, s[8:11], s68 offen sc1
s_add_u32 s55, s68, 4096
buffer_load_dwordx4 v[104:107], v7, s[8:11], s55 offen sc1
buffer_load_dwordx2 v[108:109], v2, s[8:11], s71 offen sc1
L_seta_82:
s_waitcnt vmcnt(3)
v_mfma_f32_16x16x32_bf16 v[96:99], v[40:43], v[80:83], 0
v_mfma_f32_16x16x32_bf16 v[96:99], v[40:43], v[84:87], v[96:99]
v_add_f32_dpp v78, v88, v88 quad_perm:[1,0,3,2] row_mask:0xf bank_mask:0xf
v_add_f32_dpp v79, v89, v89 quad_perm:[1,0,3,2] row_mask:0xf bank_mask:0xf
v_max3_u32 v30, v80, v81, v82
v_max3_u32 v31, v83, v84, v85
v_max3_u32 v30, v30, v86, v87
v_max3_u32 v31, v31, v88, v89
v_max_u32 v30, v30, v31
v_cmp_eq_u32 vcc, -1, v30
s_cbranch_vccnz L_setb_81
L_got_80:
v_add_f32_dpp v78, v78, v78 quad_perm:[2,3,0,1] row_mask:0xf bank_mask:0xf
v_add_f32_dpp v79, v79, v79 quad_perm:[2,3,0,1] row_mask:0xf bank_mask:0xf
v_mov_b32 v75, 0x3727c5ac
v_add_f32_dpp v78, v78, v78 row_half_mirror row_mask:0xf bank_mask:0xf
v_add_f32_dpp v79, v79, v79 row_half_mirror row_mask:0xf bank_mask:0xf
v_mul_f32 v74, v78, v78
v_fmac_f32 v75, 0x3b000000, v79
v_fmac_f32 v75, 0xb6800000, v74
v_max_f32 v75, 0x3727c5ac, v75
v_rsq_f32 v74, v75
v_pk_fma_f32 v[96:97], v[78:79], v[26:27], v[96:97] op_sel_hi:[0,1,1] neg_lo:[1,0,0] neg_hi:[1,0,0]
v_pk_mul_f32 v[96:97], v[96:97], v[74:75] op_sel_hi:[1,0]
L_vj_79:
v_max_f32 v96, 0, v96
v_mul_f32 v96, v96, v97
v_cvt_pk_bf16_f32 v96, v96, v96
ds_write_b16 v11, v96
L_hi_72:
s_cmp_ge_u32 s3, 4
s_waitcnt lgkmcnt(0)
s_barrier
s_cbranch_scc1 L_sk_89
ds_read_b128 v[64:67], v12 offset:0
ds_read_b128 v[68:71], v12 offset:64
s_waitcnt lgkmcnt(1)
v_mfma_f32_16x16x32_bf16 v[96:99], v[48:51], v[64:67], 0
s_waitcnt lgkmcnt(0)
v_mfma_f32_16x16x32_bf16 v[96:99], v[52:55], v[68:71], v[96:99]
s_add_u32 s55, s77, 131072
s_nop 6
v_cvt_pk_bf16_f32 v96, v96, v97
v_cvt_pk_bf16_f32 v97, v98, v99
buffer_store_dwordx2 v[96:97], v8, s[8:11], s55 offen sc1
s_cmp_eq_u32 s63, 0
s_cbranch_scc1 L_no_91
s_cmp_lg_u32 s6, 0
s_cbranch_scc1 L_fin
s_cmp_lg_u32 s4, s7
s_cbranch_scc1 L_fin
L_no_91:
ds_read_b64_tr_b16 v[48:49], v20 offset:0
ds_read_b64_tr_b16 v[50:51], v20 offset:1024
ds_read_b64_tr_b16 v[52:53], v20 offset:8192
ds_read_b64_tr_b16 v[54:55], v20 offset:9216
ds_read_b64_tr_b16 v[56:57], v20 offset:8
ds_read_b64_tr_b16 v[58:59], v20 offset:1032
ds_read_b64_tr_b16 v[60:61], v20 offset:8200
ds_read_b64_tr_b16 v[62:63], v20 offset:9224
s_sleep 11
s_branch L_dl_90
L_sk_89:
s_cmp_eq_u32 s63, 0
s_cbranch_scc1 L_no_92
s_cmp_lg_u32 s6, 0
s_cbranch_scc1 L_fin
s_cmp_lg_u32 s4, s7
s_cbranch_scc1 L_fin
L_no_92:
s_cmp_eq_u32 s63, 0
s_cbranch_scc1 L_fo_93
L_bk_94:
s_sleep 15
L_dl_90:
s_cmp_eq_u32 s63, 0
s_cbranch_scc1 L_fo_95
L_bk_96:
s_add_u32 s54, s72, 131072
L_retry_97:
buffer_load_dwordx4 v[64:67], v3, s[8:11], s54 offen sc1
s_add_u32 s55, s54, 8192
buffer_load_dwordx4 v[68:71], v3, s[8:11], s55 offen sc1
s_waitcnt vmcnt(0)
v_mfma_f32_16x16x32_bf16 v[96:99], v[32:35], v[64:67], 0
v_mfma_f32_16x16x32_bf16 v[96:99], v[32:35], v[68:71], v[96:99]
v_max3_u32 v30, v64, v65, v66
v_max3_u32 v31, v67, v68, v69
v_max3_u32 v30, v30, v70, v71
v_max_u32 v30, v30, v31
v_cmp_eq_u32 vcc, -1, v30
s_cbranch_vccnz L_again_99
L_got_98:
s_nop 1
v_add_f32_dpp v96, v96, v96 row_ror:4 row_mask:0xf bank_mask:0xf
v_add_f32_dpp v97, v97, v97 row_ror:4 row_mask:0xf bank_mask:0xf
s_cmp_eq_u32 s63, 1
v_add_f32_dpp v96, v96, v96 row_ror:8 row_mask:0xf bank_mask:0xf
v_add_f32_dpp v97, v97, v97 row_ror:8 row_mask:0xf bank_mask:0xf
v_pk_add_f32 v[112:113], v[112:113], v[96:97]
v_cvt_pk_bf16_f32 v96, v112, v113
s_cbranch_scc1 L_out
ds_write_b32 v14, v96
s_cmp_ge_u32 s3, 4
s_waitcnt lgkmcnt(0)
s_barrier
s_cbranch_scc1 L_up_101
ds_read_b128 v[80:83], v13
ds_read_b128 v[84:87], v13 offset:64
s_waitcnt lgkmcnt(1)
v_mfma_f32_16x16x32_bf16 v[96:99], v[48:51], v[80:83], 0
v_mfma_f32_16x16x32_bf16 v[104:107], v[56:59], v[80:83], 0
s_waitcnt lgkmcnt(0)
v_mfma_f32_16x16x32_bf16 v[96:99], v[52:55], v[84:87], v[96:99]
v_mfma_f32_16x16x32_bf16 v[104:107], v[60:63], v[84:87], v[104:107]
s_cmp_eq_u32 s60, 1
s_nop 5
v_cvt_pk_bf16_f32 v96, v96, v97
v_cvt_pk_bf16_f32 v97, v98, v99
v_cvt_pk_bf16_f32 v98, v104, v105
v_cvt_pk_bf16_f32 v99, v106, v107
s_cbranch_scc0 L_wt_102
buffer_store_dwordx4 v[96:99], v4, s[8:11], 0 offen
L_sd_103:
s_mov_b32 s63, 1
s_mov_b32 s58, 1138688
s_add_u32 s67, s67, 1138688
s_add_u32 s68, s68, 1138688
s_add_u32 s70, s70, 1138688
s_add_u32 s71, s71, 1138688
s_add_u32 s72, s72, 1138688
s_add_u32 s75, s75, 1138688
s_add_u32 s76, s76, 1138688
s_add_u32 s77, s77, 1138688
s_add_u32 s79, s79, 1138688
buffer_load_dwordx4 v[48:51], v7, s[8:11], s66 offen sc1
s_add_u32 s55, s66, 4096
buffer_load_dwordx4 v[52:55], v7, s[8:11], s55 offen sc1
buffer_load_dwordx2 v[56:57], v2, s[8:11], s69 offen sc1
s_sleep 3
buffer_load_dwordx4 v[116:119], v7, s[8:11], s66 offen sc1
s_add_u32 s55, s66, 4096
buffer_load_dwordx4 v[120:123], v7, s[8:11], s55 offen sc1
buffer_load_dwordx2 v[124:125], v2, s[8:11], s69 offen sc1
L_seta_106:
s_waitcnt vmcnt(3)
v_mfma_f32_16x16x32_bf16 v[96:99], v[32:35], v[48:51], 0
v_mfma_f32_16x16x32_bf16 v[96:99], v[32:35], v[52:55], v[96:99]
v_add_f32_dpp v78, v56, v56 quad_perm:[1,0,3,2] row_mask:0xf bank_mask:0xf
v_add_f32_dpp v79, v57, v57 quad_perm:[1,0,3,2] row_mask:0xf bank_mask:0xf
v_max3_u32 v30, v48, v49, v50
v_max3_u32 v31, v51, v52, v53
v_max3_u32 v30, v30, v54, v55
v_max3_u32 v31, v31, v56, v57
v_max_u32 v30, v30, v31
v_cmp_eq_u32 vcc, -1, v30
s_cbranch_vccnz L_setb_105
L_got_104:
v_add_f32_dpp v78, v78, v78 quad_perm:[2,3,0,1] row_mask:0xf bank_mask:0xf
v_add_f32_dpp v79, v79, v79 quad_perm:[2,3,0,1] row_mask:0xf bank_mask:0xf
v_mov_b32 v75, 0x3a21369a
v_add_f32_dpp v78, v78, v78 row_half_mirror row_mask:0xf bank_mask:0xf
v_add_f32_dpp v79, v79, v79 row_half_mirror row_mask:0xf bank_mask:0xf
v_mul_f32 v74, v78, v78
v_fmac_f32 v75, 0x3df5fdf0, v79
v_fmac_f32 v75, 0xb975fdf0, v74
v_max_f32 v75, 0x3a21369a, v75
v_rsq_f32 v74, v75
v_pk_fma_f32 v[96:97], v[78:79], v[24:25], v[96:97] op_sel_hi:[0,1,1] neg_lo:[1,0,0] neg_hi:[1,0,0]
v_pk_mul_f32 v[96:97], v[96:97], v[74:75] op_sel_hi:[1,0]
v_cvt_pk_bf16_f32 v96, v96, v97
ds_write_b32 v9, v96
L_hi_100:
s_cmp_ge_u32 s3, 4
s_waitcnt lgkmcnt(0)
s_barrier
s_cbranch_scc1 L_up_111
L_hi_110:
L_scores:
ds_read_b128 v[64:67], v10 offset:0
ds_read_b128 v[68:71], v10 offset:64
ds_read_b128 v[72:75], v10 offset:128
ds_read_b128 v[76:79], v10 offset:192
s_waitcnt lgkmcnt(3)
v_mfma_f32_16x16x32_bf16 v[80:83], a[0:3], v[64:67], 0
s_waitcnt lgkmcnt(2)
v_mfma_f32_16x16x32_bf16 v[80:83], a[4:7], v[68:71], v[80:83]
s_waitcnt lgkmcnt(1)
v_mfma_f32_16x16x32_bf16 v[80:83], a[8:11], v[72:75], v[80:83]
s_waitcnt lgkmcnt(0)
v_mfma_f32_16x16x32_bf16 v[80:83], a[12:15], v[76:79], v[80:83]
v_mfma_f32_16x16x32_bf16 v[84:87], a[16:19], v[64:67], 0
v_mfma_f32_16x16x32_bf16 v[84:87], a[20:23], v[68:71], v[84:87]
v_mfma_f32_16x16x32_bf16 v[84:87], a[24:27], v[72:75], v[84:87]
v_mfma_f32_16x16x32_bf16 v[84:87], a[28:31], v[76:79], v[84:87]
v_mfma_f32_16x16x32_bf16 v[88:91], a[32:35], v[64:67], 0
v_mfma_f32_16x16x32_bf16 v[88:91], a[36:39], v[68:71], v[88:91]
v_mfma_f32_16x16x32_bf16 v[88:91], a[40:43], v[72:75], v[88:91]
v_mfma_f32_16x16x32_bf16 v[88:91], a[44:47], v[76:79], v[88:91]
v_mfma_f32_16x16x32_bf16 v[92:95], a[48:51], v[64:67], 0
v_mfma_f32_16x16x32_bf16 v[92:95], a[52:55], v[68:71], v[92:95]
v_mfma_f32_16x16x32_bf16 v[92:95], a[56:59], v[72:75], v[92:95]
v_mfma_f32_16x16x32_bf16 v[92:95], a[60:63], v[76:79], v[92:95]
v_mov_b32_dpp v80, v84 quad_perm:[0,1,2,3] row_mask:0xf bank_mask:0x2
v_mov_b32_dpp v81, v85 quad_perm:[0,1,2,3] row_mask:0xf bank_mask:0x2
v_mov_b32_dpp v82, v86 quad_perm:[0,1,2,3] row_mask:0xf bank_mask:0x2
v_mov_b32_dpp v83, v87 quad_perm:[0,1,2,3] row_mask:0xf bank_mask:0x2
v_mov_b32_dpp v80, v88 quad_perm:[0,1,2,3] row_mask:0xf bank_mask:0x4
v_mov_b32_dpp v81, v89 quad_perm:[0,1,2,3] row_mask:0xf bank_mask:0x4
v_mov_b32_dpp v82, v90 quad_perm:[0,1,2,3] row_mask:0xf bank_mask:0x4
v_mov_b32_dpp v83, v91 quad_perm:[0,1,2,3] row_mask:0xf bank_mask:0x4
v_mov_b32_dpp v80, v92 quad_perm:[0,1,2,3] row_mask:0xf bank_mask:0x8
v_mov_b32_dpp v81, v93 quad_perm:[0,1,2,3] row_mask:0xf bank_mask:0x8
v_mov_b32_dpp v82, v94 quad_perm:[0,1,2,3] row_mask:0xf bank_mask:0x8
v_mov_b32_dpp v83, v95 quad_perm:[0,1,2,3] row_mask:0xf bank_mask:0x8
v_max3_f32 v84, v80, v81, v82
v_max_f32 v84, v84, v83
s_nop 1
v_max_f32_dpp v84, v84, v84 row_ror:4 row_mask:0xf bank_mask:0xf
s_nop 1
v_max_f32_dpp v84, v84, v84 row_ror:8 row_mask:0xf bank_mask:0xf
v_mov_b32 v85, v84
s_nop 1
v_permlane16_swap_b32 v84, v85
v_max_f32 v84, v84, v85
v_mov_b32 v85, v84
s_nop 1
v_permlane32_swap_b32 v84, v85
v_max_f32 v84, v84, v85
v_pk_add_f32 v[80:81], v[80:81], v[84:85] op_sel_hi:[1,0] neg_lo:[0,1] neg_hi:[0,1]
v_pk_add_f32 v[82:83], v[82:83], v[84:85] op_sel_hi:[1,0] neg_lo:[0,1] neg_hi:[0,1]
v_exp_f32 v80, v80
v_exp_f32 v81, v81
v_exp_f32 v82, v82
v_exp_f32 v83, v83
v_cvt_pk_bf16_f32 v86, v80, v81
v_cvt_pk_bf16_f32 v87, v82, v83
s_nop 1
v_mfma_f32_16x16x16_bf16 v[88:91], v[44:45], v[86:87], 0
s_cmp_eq_u32 s63, 0
s_cbranch_scc1 L_scored
v_mfma_f32_4x4x4_16b_bf16 v[96:99], v[86:87], a[64:65], 0 cbsz:4 abid:0
v_mfma_f32_4x4x4_16b_bf16 v[100:103], v[86:87], a[66:67], 0 cbsz:4 abid:0
v_mfma_f32_4x4x4_16b_bf16 v[104:107], v[86:87], a[68:69], 0 cbsz:4 abid:4
v_mfma_f32_4x4x4_16b_bf16 v[108:111], v[86:87], a[70:71], 0 cbsz:4 abid:4
v_mfma_f32_4x4x4_16b_bf16 v[96:99], v[86:87], a[72:73], v[96:99] cbsz:4 abid:8
v_mfma_f32_4x4x4_16b_bf16 v[100:103], v[86:87], a[74:75], v[100:103] cbsz:4 abid:8
v_mfma_f32_4x4x4_16b_bf16 v[104:107], v[86:87], a[76:77], v[104:107] cbsz:4 abid:12
v_mfma_f32_4x4x4_16b_bf16 v[108:111], v[86:87], a[78:79], v[108:111] cbsz:4 abid:12
v_mfma_f32_4x4x4_16b_bf16 v[96:99], v[86:87], a[80:81], v[96:99] cbsz:4 abid:1
v_mfma_f32_4x4x4_16b_bf16 v[100:103], v[86:87], a[82:83], v[100:103] cbsz:4 abid:1
v_mfma_f32_4x4x4_16b_bf16 v[104:107], v[86:87], a[84:85], v[104:107] cbsz:4 abid:5
v_mfma_f32_4x4x4_16b_bf16 v[108:111], v[86:87], a[86:87], v[108:111] cbsz:4 abid:5
v_add_f32_dpp v85, v88, v88 row_ror:4 row_mask:0xf bank_mask:0xf
s_nop 1
v_add_f32_dpp v85, v85, v85 row_ror:8 row_mask:0xf bank_mask:0xf
s_mov_b64 exec, 15
ds_write_b64 v18, v[84:85]
s_mov_b64 exec, -1
v_mfma_f32_4x4x4_16b_bf16 v[96:99], v[86:87], a[88:89], v[96:99] cbsz:4 abid:9
v_mfma_f32_4x4x4_16b_bf16 v[100:103], v[86:87], a[90:91], v[100:103] cbsz:4 abid:9
v_mfma_f32_4x4x4_16b_bf16 v[104:107], v[86:87], a[92:93], v[104:107] cbsz:4 abid:13
v_mfma_f32_4x4x4_16b_bf16 v[108:111], v[86:87], a[94:95], v[108:111] cbsz:4 abid:13
v_mfma_f32_4x4x4_16b_bf16 v[96:99], v[86:87], a[96:97], v[96:99] cbsz:4 abid:2
v_mfma_f32_4x4x4_16b_bf16 v[100:103], v[86:87], a[98:99], v[100:103] cbsz:4 abid:2
v_mfma_f32_4x4x4_16b_bf16 v[104:107], v[86:87], a[100:101], v[104:107] cbsz:4 abid:6
v_mfma_f32_4x4x4_16b_bf16 v[108:111], v[86:87], a[102:103], v[108:111] cbsz:4 abid:6
v_mfma_f32_4x4x4_16b_bf16 v[96:99], v[86:87], a[104:105], v[96:99] cbsz:4 abid:10
v_mfma_f32_4x4x4_16b_bf16 v[100:103], v[86:87], a[106:107], v[100:103] cbsz:4 abid:10
v_mfma_f32_4x4x4_16b_bf16 v[104:107], v[86:87], a[108:109], v[104:107] cbsz:4 abid:14
v_mfma_f32_4x4x4_16b_bf16 v[108:111], v[86:87], a[110:111], v[108:111] cbsz:4 abid:14
v_mfma_f32_4x4x4_16b_bf16 v[96:99], v[86:87], a[112:113], v[96:99] cbsz:4 abid:3
v_mfma_f32_4x4x4_16b_bf16 v[100:103], v[86:87], a[114:115], v[100:103] cbsz:4 abid:3
v_mfma_f32_4x4x4_16b_bf16 v[104:107], v[86:87], a[116:117], v[104:107] cbsz:4 abid:7
v_mfma_f32_4x4x4_16b_bf16 v[108:111], v[86:87], a[118:119], v[108:111] cbsz:4 abid:7
v_mfma_f32_4x4x4_16b_bf16 v[96:99], v[86:87], a[120:121], v[96:99] cbsz:4 abid:11
v_mfma_f32_4x4x4_16b_bf16 v[100:103], v[86:87], a[122:123], v[100:103] cbsz:4 abid:11
v_mfma_f32_4x4x4_16b_bf16 v[104:107], v[86:87], a[124:125], v[104:107] cbsz:4 abid:15
v_mfma_f32_4x4x4_16b_bf16 v[108:111], v[86:87], a[126:127], v[108:111] cbsz:4 abid:15
s_branch L_merge
L_out:
s_mov_b64 exec, s[88:89]
buffer_store_dword v96, v23, s[44:47], 0 offen
s_or_b32 s55, s2, s3
s_cmp_lg_u32 s55, 0
s_cbranch_scc1 L_fin0
s_mov_b64 exec, 1
v_mov_b32 v97, s100
s_mov_b32 s56, 3588096
buffer_store_dword v97, off, s[8:11], s56 sc1
L_fin0:
s_mov_b64 exec, -1
L_fin:
s_endpgm
L_rt_24:
s_sub_u32 s59, s59, 1
s_cbranch_scc0 L_rm_22
s_mov_b32 s59, 0
s_branch L_rd_23
L_wt_27:
buffer_store_dwordx2 v[74:75], v46, s[8:11], s76 offen sc1
s_branch L_sd_28
L_wt_29:
buffer_store_dwordx4 v[74:77], v46, s[8:11], s55 offen sc1
s_branch L_sd_30
L_v0_25:
s_nop 0
v_mov_b32 v76, s100
v_mov_b32 v77, s100
s_lshl_b32 s55, s4, 2
s_add_u32 s55, s55, s3
s_lshl_b32 s55, s55, 2
s_add_u32 s55, s55, s6
s_lshl_b32 s55, s55, 3
s_add_u32 s55, s55, s7
s_lshl_b32 s55, s55, 4
s_add_u32 s55, s55, 3538944
s_cmp_eq_u32 s60, 1
s_cbranch_scc0 L_wt_29
buffer_store_dwordx4 v[74:77], v46, s[8:11], s55 offen
L_sd_30:
s_branch L_vj_26
L_wt_35:
buffer_store_dword v64, v15, s[8:11], s75 offen sc1
s_branch L_sd_36
L_wt_37:
buffer_store_dwordx4 v[64:67], v118, s[8:11], 0 offen sc1
s_branch L_sd_38
L_v0_33:
s_nop 0
v_mov_b32 v66, s100
v_mov_b32 v67, s100
v_mov_b32_dpp v65, v64 quad_perm:[1,1,3,3] row_mask:0xf bank_mask:0xf
s_cmp_eq_u32 s60, 1
s_cbranch_scc0 L_wt_37
buffer_store_dwordx4 v[64:67], v118, s[8:11], 0 offen
L_sd_38:
v_mov_b32 v76, -1
v_mov_b32 v77, -1
ds_write_b64 v19, v[76:77]
s_branch L_vj_34
L_fo_39:
s_cmp_lg_u32 s3, 7
s_cbranch_scc1 L_c7_41
s_lshl_b32 s55, s2, 7
s_add_u32 s55, s55, 3555328
v_mov_b32 v69, s100
s_mov_b32 exec_hi, 0
s_waitcnt vmcnt(3)
buffer_store_dword v69, v15, s[8:11], s55 offen sc1
s_mov_b64 exec, -1
L_c7_41:
s_lshl_b32 s55, s7, 3
s_add_u32 s55, s55, s3
s_mul_i32 s55, s55, 28672
s_lshl_b32 s56, s92, 7
s_add_u32 s81, s55, s56
s_sub_u32 s80, s81, 114688
s_lshl_b32 s55, s92, 3
s_add_u32 s55, s55, s3
s_lshl_b32 s55, s55, 6
s_add_u32 s55, s55, s7
s_lshl_b32 s83, s55, 7
s_sub_u32 s82, s83, 32768
s_lshl_b32 s84, s3, 10
s_sub_u32 s84, s84, 4096
s_lshl_b32 s55, s7, 10
s_lshl_b32 s56, s4, 7
v_and_b32 v68, 7, v0
v_and_b32 v69, 24, v0
v_lshlrev_b32 v68, 7, v68
v_lshl_add_u32 v68, v69, 10, v68
v_add_u32 v68, s55, v68
v_and_b32 v69, 31, v0
v_lshlrev_b32 v69, 10, v69
v_add_u32 v69, s56, v69
v_cmp_lt_u32 vcc, 31, v0
s_nop 1
v_cndmask_b32 v68, v68, v69, vcc
s_mov_b32 s55, 3555328
v_mov_b32 v114, v68
s_mov_b32 s85, 3555328
s_waitcnt vmcnt(0)
s_branch L_bk_40
L_up_32:
s_cmp_eq_u32 s63, 0
s_cbranch_scc1 L_fo_39
L_bk_40:
s_branch L_hi_31
L_again_48:
s_sub_u32 s59, s59, 1
s_cbranch_scc0 L_retry_46
s_mov_b32 s59, 0
s_branch L_got_47
L_setb_50:
buffer_load_dwordx4 v[100:103], v7, s[8:11], s67 offen sc1
s_add_u32 s55, s67, 4096
buffer_load_dwordx4 v[104:107], v7, s[8:11], s55 offen sc1
s_waitcnt vmcnt(2)
s_nop 3
v_mfma_f32_16x16x32_bf16 v[96:99], v[80:83], v[116:119], 0
v_mfma_f32_16x16x32_bf16 v[96:99], v[84:87], v[120:123], v[96:99]
v_max3_u32 v30, v116, v117, v118
v_max3_u32 v31, v119, v120, v121
v_max3_u32 v30, v30, v122, v123
v_max_u32 v30, v30, v31
v_cmp_eq_u32 vcc, -1, v30
s_nop 3
s_cbranch_vccz L_got_49
buffer_load_dwordx4 v[116:119], v7, s[8:11], s67 offen sc1
s_add_u32 s55, s67, 4096
buffer_load_dwordx4 v[120:123], v7, s[8:11], s55 offen sc1
s_sub_u32 s59, s59, 1
s_cbranch_scc0 L_seta_51
s_mov_b32 s59, 0
s_branch L_got_49
L_v0_44:
v_and_b32 v31, 0xf0, v7
v_lshlrev_b32 v30, 1, v7
v_sub_u32 v30, v30, v31
s_lshl_b32 s55, s4, 2
s_add_u32 s55, s55, s6
s_lshl_b32 s54, s55, 2
s_lshl_b32 s55, s55, 14
s_add_u32 s55, s55, 3014656
s_add_u32 s56, s55, 8192
buffer_load_dwordx4 v[80:83], v30, s[8:11], s55 offen offset:0 sc1
buffer_load_dwordx4 v[84:87], v30, s[8:11], s55 offen offset:256 sc1
buffer_load_dwordx4 v[88:91], v30, s[8:11], s56 offen offset:0 sc1
buffer_load_dwordx4 v[92:95], v30, s[8:11], s56 offen offset:256 sc1
s_add_u32 s54, s54, s3
s_lshl_b32 s54, s54, 7
s_add_u32 s54, s54, 3538944
v_lshlrev_b32 v31, 1, v29
buffer_load_dwordx4 v[64:67], v31, s[8:11], s54 offen sc1
buffer_load_dwordx4 v[68:71], v31, s[8:11], s54 offen offset:64 sc1
s_sleep 3
L_lp_52:
v_and_b32 v31, 0xf0, v7
v_lshlrev_b32 v30, 1, v7
v_sub_u32 v30, v30, v31
s_lshl_b32 s55, s4, 2
s_add_u32 s55, s55, s6
s_lshl_b32 s54, s55, 2
s_lshl_b32 s55, s55, 14
s_add_u32 s55, s55, 3014656
s_add_u32 s56, s55, 8192
buffer_load_dwordx4 v[48:51], v30, s[8:11], s55 offen offset:0 sc1
buffer_load_dwordx4 v[52:55], v30, s[8:11], s55 offen offset:256 sc1
buffer_load_dwordx4 v[56:59], v30, s[8:11], s56 offen offset:0 sc1
buffer_load_dwordx4 v[60:63], v30, s[8:11], s56 offen offset:256 sc1
s_add_u32 s54, s54, s3
s_lshl_b32 s54, s54, 7
s_add_u32 s54, s54, 3538944
v_lshlrev_b32 v31, 1, v29
buffer_load_dwordx4 v[100:103], v31, s[8:11], s54 offen sc1
buffer_load_dwordx4 v[104:107], v31, s[8:11], s54 offen offset:64 sc1
s_waitcnt vmcnt(6)
v_xor_b32 v30, s100, v82
v_xor_b32 v31, s100, v86
v_or_b32 v30, v30, v31
v_xor_b32 v31, s100, v90
v_or_b32 v30, v30, v31
v_xor_b32 v31, s100, v94
v_or_b32 v30, v30, v31
v_xor_b32 v31, s100, v66
v_or_b32 v30, v30, v31
v_xor_b32 v31, s100, v70
v_or_b32 v30, v30, v31
v_cmp_ne_u32 vcc, 0, v30
s_cbranch_vccz L_ga_53
v_and_b32 v31, 0xf0, v7
v_lshlrev_b32 v30, 1, v7
v_sub_u32 v30, v30, v31
s_lshl_b32 s55, s4, 2
s_add_u32 s55, s55, s6
s_lshl_b32 s54, s55, 2
s_lshl_b32 s55, s55, 14
s_add_u32 s55, s55, 3014656
s_add_u32 s56, s55, 8192
buffer_load_dwordx4 v[80:83], v30, s[8:11], s55 offen offset:0 sc1
buffer_load_dwordx4 v[84:87], v30, s[8:11], s55 offen offset:256 sc1
buffer_load_dwordx4 v[88:91], v30, s[8:11], s56 offen offset:0 sc1
buffer_load_dwordx4 v[92:95], v30, s[8:11], s56 offen offset:256 sc1
s_add_u32 s54, s54, s3
s_lshl_b32 s54, s54, 7
s_add_u32 s54, s54, 3538944
v_lshlrev_b32 v31, 1, v29
buffer_load_dwordx4 v[64:67], v31, s[8:11], s54 offen sc1
buffer_load_dwordx4 v[68:71], v31, s[8:11], s54 offen offset:64 sc1
s_waitcnt vmcnt(6)
v_xor_b32 v30, s100, v50
v_xor_b32 v31, s100, v54
v_or_b32 v30, v30, v31
v_xor_b32 v31, s100, v58
v_or_b32 v30, v30, v31
v_xor_b32 v31, s100, v62
v_or_b32 v30, v30, v31
v_xor_b32 v31, s100, v102
v_or_b32 v30, v30, v31
v_xor_b32 v31, s100, v106
v_or_b32 v30, v30, v31
v_cmp_ne_u32 vcc, 0, v30
s_cbranch_vccz L_gb_54
s_sub_u32 s59, s59, 1
s_cbranch_scc0 L_lp_52
s_mov_b32 s59, 0
L_gb_54:
v_max_f32 v76, v100, v104
v_mov_b32 v77, v76
s_nop 1
v_permlane16_swap_b32 v76, v77
v_max_f32 v76, v76, v77
v_mov_b32 v77, v76
s_nop 1
v_permlane32_swap_b32 v76, v77
v_max_f32 v76, v76, v77
v_sub_f32 v100, v100, v76
v_sub_f32 v104, v104, v76
v_exp_f32 v100, v100
v_exp_f32 v104, v104
v_cvt_pk_bf16_f32 v100, v100, v100
v_cvt_pk_bf16_f32 v104, v104, v104
v_and_b32 v116, v36, v100
v_and_b32 v117, v37, v100
v_and_b32 v118, v38, v100
v_and_b32 v119, v39, v100
v_and_b32 v120, v36, v104
v_and_b32 v121, v37, v104
v_and_b32 v122, v38, v104
v_and_b32 v123, v39, v104
v_mfma_f32_16x16x16_bf16 v[96:99], v[116:117], v[48:49], 0
v_mfma_f32_16x16x16_bf16 v[96:99], v[118:119], v[52:53], v[96:99]
v_mfma_f32_16x16x16_bf16 v[96:99], v[120:121], v[56:57], v[96:99]
v_mfma_f32_16x16x16_bf16 v[96:99], v[122:123], v[60:61], v[96:99]
v_and_b32 v100, 0xffff0000, v100
v_and_b32 v104, 0xffff0000, v104
v_mul_f32 v79, v101, v100
v_fmac_f32 v79, v105, v104
v_mov_b32 v77, v79
s_nop 1
v_permlane16_swap_b32 v79, v77
v_add_f32 v79, v79, v77
v_mov_b32 v77, v79
s_nop 1
v_permlane32_swap_b32 v79, v77
v_add_f32 v79, v79, v77
v_rcp_f32 v78, v79
s_branch L_en_55
L_ga_53:
v_max_f32 v76, v64, v68
v_mov_b32 v77, v76
s_nop 1
v_permlane16_swap_b32 v76, v77
v_max_f32 v76, v76, v77
v_mov_b32 v77, v76
s_nop 1
v_permlane32_swap_b32 v76, v77
v_max_f32 v76, v76, v77
v_sub_f32 v64, v64, v76
v_sub_f32 v68, v68, v76
v_exp_f32 v64, v64
v_exp_f32 v68, v68
v_cvt_pk_bf16_f32 v64, v64, v64
v_cvt_pk_bf16_f32 v68, v68, v68
v_and_b32 v116, v36, v64
v_and_b32 v117, v37, v64
v_and_b32 v118, v38, v64
v_and_b32 v119, v39, v64
v_and_b32 v120, v36, v68
v_and_b32 v121, v37, v68
v_and_b32 v122, v38, v68
v_and_b32 v123, v39, v68
v_mfma_f32_16x16x16_bf16 v[96:99], v[116:117], v[80:81], 0
v_mfma_f32_16x16x16_bf16 v[96:99], v[118:119], v[84:85], v[96:99]
v_mfma_f32_16x16x16_bf16 v[96:99], v[120:121], v[88:89], v[96:99]
v_mfma_f32_16x16x16_bf16 v[96:99], v[122:123], v[92:93], v[96:99]
v_and_b32 v64, 0xffff0000, v64
v_and_b32 v68, 0xffff0000, v68
v_mul_f32 v79, v65, v64
v_fmac_f32 v79, v69, v68
v_mov_b32 v77, v79
s_nop 1
v_permlane16_swap_b32 v79, v77
v_add_f32 v79, v79, v77
v_mov_b32 v77, v79
s_nop 1
v_permlane32_swap_b32 v79, v77
v_add_f32 v79, v79, v77
v_rcp_f32 v78, v79
L_en_55:
s_waitcnt vmcnt(0)
s_branch L_vj_45
L_v0_58:
ds_read_b64_tr_b16 v[48:49], v22 offset:0
ds_read_b64_tr_b16 v[50:51], v22 offset:256
ds_read_b64_tr_b16 v[52:53], v22 offset:2048
ds_read_b64_tr_b16 v[54:55], v22 offset:2304
ds_read_b64_tr_b16 v[56:57], v22 offset:4096
ds_read_b64_tr_b16 v[58:59], v22 offset:4352
ds_read_b64_tr_b16 v[60:61], v22 offset:6144
ds_read_b64_tr_b16 v[62:63], v22 offset:6400
s_waitcnt lgkmcnt(0)
v_mfma_f32_16x16x32_bf16 v[96:99], v[48:51], v[64:67], 0
v_mfma_f32_16x16x32_bf16 v[96:99], v[52:55], v[68:71], v[96:99]
v_mfma_f32_16x16x32_bf16 v[96:99], v[56:59], v[72:75], v[96:99]
v_mfma_f32_16x16x32_bf16 v[96:99], v[60:63], v[76:79], v[96:99]
s_add_u32 s55, s77, 0
s_nop 6
v_cvt_pk_bf16_f32 v96, v96, v97
v_cvt_pk_bf16_f32 v97, v98, v99
buffer_store_dwordx2 v[96:97], v8, s[8:11], s55 offen sc1
s_branch L_vj_59
L_aw_61_hi:
s_cmp_lg_u32 s3, 4
s_cbranch_scc1 L_fo_62
buffer_load_dword v69, v114, s[8:11], s85 offen sc1
s_add_u32 m0, s84, 98304
s_nop 0
buffer_load_dwordx4 v126, s[28:31], s80 offen nt lds
s_add_u32 m0, s84, 106496
s_nop 0
buffer_load_dwordx4 v126, s[32:35], s80 offen nt lds
s_add_u32 m0, s84, 102400
s_nop 0
buffer_load_dwordx4 v126, s[28:31], s81 offen nt lds
s_add_u32 m0, s84, 110592
s_nop 0
buffer_load_dwordx4 v126, s[32:35], s81 offen nt lds
s_waitcnt vmcnt(4)
v_cmp_ne_u32 vcc, s100, v69
s_cbranch_vccz L_fd_65
L_fr_63:
s_sleep 4
buffer_load_dword v69, v114, s[8:11], s85 offen sc1
s_waitcnt vmcnt(0)
v_cmp_ne_u32 vcc, s100, v69
s_cbranch_vccz L_fe_64
s_sub_u32 s59, s59, 1
s_cbranch_scc0 L_fr_63
s_mov_b32 s59, 0
L_fe_64:
L_fd_65:
v_mov_b32 v68, 127440
v_mov_b32 v69, 1
ds_write_b32 v68, v69
s_sleep 4
s_branch L_aw_61
L_fo_62:
s_sleep 1
s_add_u32 m0, s84, 98304
s_nop 0
buffer_load_dwordx4 v126, s[28:31], s80 offen nt lds
s_add_u32 m0, s84, 106496
s_nop 0
buffer_load_dwordx4 v126, s[32:35], s80 offen nt lds
s_add_u32 m0, s84, 102400
s_nop 0
buffer_load_dwordx4 v126, s[28:31], s81 offen nt lds
s_add_u32 m0, s84, 110592
s_nop 0
buffer_load_dwordx4 v126, s[32:35], s81 offen nt lds
s_cmp_lg_u32 s3, 7
s_cbranch_scc1 L_cr_66
v_mov_b32 v64, -1
v_mov_b32 v65, -1
v_mov_b32 v66, -1
v_mov_b32 v67, -1
v_lshlrev_b32 v68, 2, v15
s_add_u32 s55, s77, 1138688
v_add_u32 v69, 130560, v68
v_cmp_lt_u32 vcc, 31, v0
s_nop 1
v_cndmask_b32 v69, v68, v69, vcc
buffer_store_dwordx4 v[64:67], v69, s[8:11], s55 offen sc1
s_mul_i32 s56, s5, 3168
s_add_u32 s56, s56, s73
s_add_u32 s56, s56, 1138688
buffer_store_dwordx4 v[64:67], v68, s[8:11], s56 offen offset:0 sc1
buffer_store_dwordx4 v[64:67], v68, s[8:11], s56 offen offset:1024 sc1
buffer_store_dwordx4 v[64:67], v68, s[8:11], s56 offen offset:2048 sc1
s_mov_b64 exec, 63
buffer_store_dwordx4 v[64:67], v68, s[8:11], s56 offen offset:3072 sc1
s_mov_b64 exec, -1
L_cr_66:
s_sleep 15
s_branch L_aw_61
L_aw_61_lo:
s_sleep 12
L_aw_61:
v_mov_b32 v68, 127440
L_ar_67:
ds_read_b32 v69, v68
s_waitcnt lgkmcnt(0)
v_cmp_eq_u32 vcc, 1, v69
s_cbranch_vccnz L_ad_68
s_sleep 1
s_sub_u32 s59, s59, 1
s_cbranch_scc0 L_ar_67
s_mov_b32 s59, 0
L_ad_68:
s_branch L_go_60
L_again_71:
s_sub_u32 s59, s59, 1
s_cbranch_scc0 L_retry_69
s_mov_b32 s59, 0
s_branch L_got_70
L_fo_74:
ds_read_b64_tr_b16 v[48:49], v21 offset:0
ds_read_b64_tr_b16 v[50:51], v21 offset:512
ds_read_b64_tr_b16 v[52:53], v21 offset:4096
ds_read_b64_tr_b16 v[54:55], v21 offset:4608
ds_read_b64_tr_b16 v[56:57], v21 offset:8192
ds_read_b64_tr_b16 v[58:59], v21 offset:8704
ds_read_b64_tr_b16 v[60:61], v21 offset:12288
ds_read_b64_tr_b16 v[62:63], v21 offset:12800
s_branch L_bk_75
L_wt_76:
buffer_store_dwordx4 v[96:99], v5, s[8:11], s58 offen sc1
s_branch L_sd_77
L_setb_81:
buffer_load_dwordx4 v[80:83], v7, s[8:11], s68 offen sc1
s_add_u32 s55, s68, 4096
buffer_load_dwordx4 v[84:87], v7, s[8:11], s55 offen sc1
buffer_load_dwordx2 v[88:89], v2, s[8:11], s71 offen sc1
s_waitcnt vmcnt(3)
s_nop 1
v_mfma_f32_16x16x32_bf16 v[96:99], v[40:43], v[100:103], 0
v_mfma_f32_16x16x32_bf16 v[96:99], v[40:43], v[104:107], v[96:99]
v_add_f32_dpp v78, v108, v108 quad_perm:[1,0,3,2] row_mask:0xf bank_mask:0xf
v_add_f32_dpp v79, v109, v109 quad_perm:[1,0,3,2] row_mask:0xf bank_mask:0xf
v_max3_u32 v30, v100, v101, v102
v_max3_u32 v31, v103, v104, v105
v_max3_u32 v30, v30, v106, v107
v_max3_u32 v31, v31, v108, v109
v_max_u32 v30, v30, v31
v_cmp_eq_u32 vcc, -1, v30
s_nop 1
s_cbranch_vccz L_got_80
buffer_load_dwordx4 v[100:103], v7, s[8:11], s68 offen sc1
s_add_u32 s55, s68, 4096
buffer_load_dwordx4 v[104:107], v7, s[8:11], s55 offen sc1
buffer_load_dwordx2 v[108:109], v2, s[8:11], s71 offen sc1
s_sub_u32 s59, s59, 1
s_cbranch_scc0 L_seta_82
s_mov_b32 s59, 0
s_branch L_got_80
L_again_85:
s_sub_u32 s59, s59, 1
s_cbranch_scc0 L_retry_83
s_mov_b32 s59, 0
s_branch L_got_84
L_v0_78:
L_retry_83:
buffer_load_dwordx4 v[64:67], v7, s[8:11], s68 offen sc1
s_add_u32 s55, s68, 4096
buffer_load_dwordx4 v[68:71], v7, s[8:11], s55 offen sc1
buffer_load_dwordx2 v[72:73], v2, s[8:11], s71 offen sc1
v_and_b32 v30, 0xf0, v7
v_and_b32 v31, 0xc00, v7
v_lshrrev_b32 v31, 2, v31
v_or_b32 v30, v30, v31
buffer_load_dwordx4 v[80:83], v30, s[8:11], s74 offen sc1
buffer_load_dwordx4 v[84:87], v30, s[8:11], s74 offen offset:1024 sc1
s_waitcnt vmcnt(0)
v_mfma_f32_16x16x32_bf16 v[96:99], v[40:43], v[64:67], 0
v_mfma_f32_16x16x32_bf16 v[96:99], v[40:43], v[68:71], v[96:99]
v_mfma_f32_16x16x32_bf16 v[100:103], v[40:43], v[80:83], 0
v_mfma_f32_16x16x32_bf16 v[100:103], v[40:43], v[84:87], v[100:103]
v_add_f32_dpp v78, v72, v72 quad_perm:[1,0,3,2] row_mask:0xf bank_mask:0xf
v_add_f32_dpp v79, v73, v73 quad_perm:[1,0,3,2] row_mask:0xf bank_mask:0xf
v_max3_u32 v30, v64, v65, v66
v_max3_u32 v31, v67, v68, v69
v_max3_u32 v30, v30, v70, v71
v_max3_u32 v31, v31, v72, v73
v_max3_u32 v30, v30, v80, v81
v_max3_u32 v31, v31, v82, v83
v_max3_u32 v30, v30, v84, v85
v_max3_u32 v31, v31, v86, v87
v_max_u32 v30, v30, v31
v_cmp_eq_u32 vcc, -1, v30
s_cbranch_vccnz L_again_85
L_got_84:
v_add_f32_dpp v78, v78, v78 quad_perm:[2,3,0,1] row_mask:0xf bank_mask:0xf
v_add_f32_dpp v79, v79, v79 quad_perm:[2,3,0,1] row_mask:0xf bank_mask:0xf
v_mov_b32 v75, 0x3727c5ac
v_add_f32_dpp v78, v78, v78 row_half_mirror row_mask:0xf bank_mask:0xf
v_add_f32_dpp v79, v79, v79 row_half_mirror row_mask:0xf bank_mask:0xf
v_mul_f32 v74, v78, v78
v_fmac_f32 v75, 0x3b000000, v79
s_mov_b32 s56, 0x3b000000
v_pk_mul_f32 v[26:27], v[100:101], s[56:57] op_sel_hi:[1,0]
v_fmac_f32 v75, 0xb6800000, v74
v_max_f32 v75, 0x3727c5ac, v75
v_rsq_f32 v74, v75
v_pk_fma_f32 v[96:97], v[78:79], v[26:27], v[96:97] op_sel_hi:[0,1,1] neg_lo:[1,0,0] neg_hi:[1,0,0]
v_pk_mul_f32 v[96:97], v[96:97], v[74:75] op_sel_hi:[1,0]
s_branch L_vj_79
L_wt_87:
buffer_store_dword v104, v6, s[8:11], s79 offen sc1
s_branch L_sd_88
L_up_73:
s_cmp_lg_u32 s3, 4
s_cbranch_scc1 L_st_86
ds_read_b128 v[80:83], v13
ds_read_b128 v[84:87], v13 offset:64
s_waitcnt lgkmcnt(1)
v_mfma_f32_16x16x32_bf16 v[104:107], v[80:83], v[80:83], 0
s_waitcnt lgkmcnt(0)
v_mfma_f32_16x16x32_bf16 v[104:107], v[84:87], v[84:87], v[104:107]
s_mov_b64 s[80:81], 10
s_mov_b64 s[82:83], 12
s_cmp_eq_u32 s60, 1
s_nop 4
v_cndmask_b32 v104, v104, v105, s[80:81]
v_cndmask_b32 v106, v106, v107, s[80:81]
v_cndmask_b32 v104, v104, v106, s[82:83]
s_cbranch_scc0 L_wt_87
buffer_store_dword v104, v6, s[8:11], s79 offen
L_sd_88:
L_st_86:
s_branch L_hi_72
L_fo_93:
s_add_u32 s54, s66, 0
s_add_u32 s55, s54, 4096
buffer_load_dwordx4 v[80:83], v7, s[8:11], s54 offen sc1
buffer_load_dwordx4 v[84:87], v7, s[8:11], s55 offen sc1
s_add_u32 s54, s69, 0
buffer_load_dwordx2 v[88:89], v2, s[8:11], s54 offen sc1
s_branch L_bk_94
L_fo_95:
s_sleep 8
s_branch L_bk_96
L_again_99:
s_sub_u32 s59, s59, 1
s_cbranch_scc0 L_retry_97
s_mov_b32 s59, 0
s_branch L_got_98
L_wt_102:
buffer_store_dwordx4 v[96:99], v4, s[8:11], 0 offen sc1
s_branch L_sd_103
L_setb_105:
buffer_load_dwordx4 v[48:51], v7, s[8:11], s66 offen sc1
s_add_u32 s55, s66, 4096
buffer_load_dwordx4 v[52:55], v7, s[8:11], s55 offen sc1
buffer_load_dwordx2 v[56:57], v2, s[8:11], s69 offen sc1
s_waitcnt vmcnt(3)
s_nop 1
v_mfma_f32_16x16x32_bf16 v[96:99], v[32:35], v[116:119], 0
v_mfma_f32_16x16x32_bf16 v[96:99], v[32:35], v[120:123], v[96:99]
v_add_f32_dpp v78, v124, v124 quad_perm:[1,0,3,2] row_mask:0xf bank_mask:0xf
v_add_f32_dpp v79, v125, v125 quad_perm:[1,0,3,2] row_mask:0xf bank_mask:0xf
v_max3_u32 v30, v116, v117, v118
v_max3_u32 v31, v119, v120, v121
v_max3_u32 v30, v30, v122, v123
v_max3_u32 v31, v31, v124, v125
v_max_u32 v30, v30, v31
v_cmp_eq_u32 vcc, -1, v30
s_nop 1
s_cbranch_vccz L_got_104
buffer_load_dwordx4 v[116:119], v7, s[8:11], s66 offen sc1
s_add_u32 s55, s66, 4096
buffer_load_dwordx4 v[120:123], v7, s[8:11], s55 offen sc1
buffer_load_dwordx2 v[124:125], v2, s[8:11], s69 offen sc1
s_sub_u32 s59, s59, 1
s_cbranch_scc0 L_seta_106
s_mov_b32 s59, 0
s_branch L_got_104
L_wt_108:
buffer_store_dword v104, v6, s[8:11], s78 offen sc1
s_branch L_sd_109
L_up_101:
s_cmp_lg_u32 s3, 4
s_cbranch_scc1 L_st_107
ds_read_b128 v[80:83], v13
ds_read_b128 v[84:87], v13 offset:64
s_waitcnt lgkmcnt(1)
v_mfma_f32_16x16x32_bf16 v[104:107], v[80:83], v[80:83], 0
s_waitcnt lgkmcnt(0)
v_mfma_f32_16x16x32_bf16 v[104:107], v[84:87], v[84:87], v[104:107]
s_mov_b64 s[80:81], 10
s_mov_b64 s[82:83], 12
s_cmp_eq_u32 s60, 1
s_nop 4
v_cndmask_b32 v104, v104, v105, s[80:81]
v_cndmask_b32 v106, v106, v107, s[80:81]
v_cndmask_b32 v104, v104, v106, s[82:83]
s_cbranch_scc0 L_wt_108
buffer_store_dword v104, v6, s[8:11], s78 offen
L_sd_109:
L_st_107:
s_mov_b32 s63, 1
s_mov_b32 s58, 1138688
s_add_u32 s67, s67, 1138688
s_add_u32 s68, s68, 1138688
s_add_u32 s70, s70, 1138688
s_add_u32 s71, s71, 1138688
s_add_u32 s72, s72, 1138688
s_add_u32 s75, s75, 1138688
s_add_u32 s76, s76, 1138688
s_add_u32 s77, s77, 1138688
s_add_u32 s79, s79, 1138688
s_branch L_hi_100
L_up_111:
s_add_u32 s54, s67, 0
s_add_u32 s55, s54, 4096
buffer_load_dwordx4 v[48:51], v7, s[8:11], s54 offen sc1
buffer_load_dwordx4 v[52:55], v7, s[8:11], s55 offen sc1
s_add_u32 s54, s68, 0
s_add_u32 s55, s54, 4096
buffer_load_dwordx4 v[48:51], v7, s[8:11], s54 offen sc1
buffer_load_dwordx4 v[52:55], v7, s[8:11], s55 offen sc1
s_add_u32 s54, s70, 0
buffer_load_dwordx2 v[56:57], v2, s[8:11], s54 offen sc1
s_add_u32 s54, s71, 0
buffer_load_dwordx2 v[56:57], v2, s[8:11], s54 offen sc1
s_branch L_hi_110
L_end:
s_endpgm
.section .rodata,"a"
.p2align 6
.amdhsa_kernel interleave_layers__sliding_block_cached__glu_gated_reglu__decode_kernel
.amdhsa_next_free_vgpr 256
.amdhsa_next_free_sgpr 102
.amdhsa_accum_offset 128
.amdhsa_group_segment_fixed_size 0
.amdhsa_kernarg_size 96
.amdhsa_user_sgpr_count 2
.amdhsa_user_sgpr_kernarg_segment_ptr 1
.amdhsa_system_sgpr_workgroup_id_x 1
.end_amdhsa_kernel
```
